```python
import torch

def _softmax(x, axis=-1):
    return torch.softmax(x, dim=axis)
def _gelu(x):
    return torch.nn.functional.gelu(x, approximate="tanh")
def _silu(x):
    return torch.nn.functional.silu(x)
def _sigmoid(x):
    return torch.sigmoid(x)
def _layernorm(x, axis=-1, eps=1e-5):
    m = x.mean(dim=axis, keepdim=True)
    v = x.var(dim=axis, keepdim=True, unbiased=False)
    return (x - m) / torch.sqrt(v + eps)
def _scatter_add(tgt, idx, src, axis=0):
    return tgt.clone().index_add_(axis, idx, src)
def _segment_sum(src, seg, n):
    out = torch.zeros((n,) + src.shape[1:], dtype=src.dtype)
    return out.index_add_(0, seg, src)
def _pad(x, pw):
    flat = tuple(v for pair in reversed(pw) for v in pair)
    return torch.nn.functional.pad(x, flat)

kernel_name = 'gated_mix__mha_block_cached__dense_activation_mish__decode'

def setup_inputs():

    _w = (lambda a: (lambda t: t.to(torch.bfloat16) if t.is_floating_point() else t)(torch.as_tensor(a)))
    def _A_setup():
        B, Sq, D = 2, 1, 576
        H, Sk, Dh = 32, 8192, 128
        return {
            "x": _w((lambda *s: torch.randn(*s, dtype=torch.bfloat16) * 0.05)(B, Sq, D)),
            "k_cache": _w((lambda *s: torch.randn(*s, dtype=torch.bfloat16) * 6.4)(B, H, Sk, Dh)),
            "v_cache": _w((lambda *s: torch.randn(*s, dtype=torch.bfloat16) * 0.2)(B, H, Sk, Dh)),
            "wq": _w((lambda *s: torch.randn(*s, dtype=torch.bfloat16) * 6.4)(D, H * Dh) * (D ** -0.5)),
            "wo": _w((lambda *s: torch.randn(*s, dtype=torch.bfloat16) * 0.2)(H * Dh, D) * ((H * Dh) ** -0.5)),
        }
    _A_in = _A_setup()

    def _B_setup():
        B, S, D, F = 2, 1, 576, 4608
        return {
            "x": _w((lambda *s: torch.randn(*s, dtype=torch.bfloat16) * 0.05)(B, S, D)),
            "w1": _w((lambda *s: torch.randn(*s, dtype=torch.bfloat16) * 3.2)(D, F) * (D ** -0.5)),
            "b1": _w((lambda *s: torch.randn(*s, dtype=torch.bfloat16) * 0.05)(F)),
            "w2": _w((lambda *s: torch.randn(*s, dtype=torch.bfloat16) * 0.05)(F, D) * (F ** -0.5)),
        }
    _B_in = _B_setup()

    return {
        "A_x": _A_in["x"],
        "A_k_cache": _A_in["k_cache"],
        "A_v_cache": _A_in["v_cache"],
        "A_wq": _A_in["wq"],
        "A_wo": _A_in["wo"],
        "B_x": _B_in["x"],
        "B_w1": _B_in["w1"],
        "B_b1": _B_in["b1"],
        "B_w2": _B_in["w2"],
        "gate_w": _w((lambda *s: torch.randn(*s, dtype=torch.bfloat16) * 0.05)(576) * 16.0),
    }

def reference(A_x, A_k_cache, A_v_cache, A_wq, A_wo, B_x, B_w1, B_b1, B_w2, gate_w):
    def _A_ref(x, k_cache, v_cache, wq, wo):
        B, Sq, D = x.shape
        H, Dh = 32, 128
        q = (lambda x, *d: x.permute(*d))((x @ wq).reshape(B, Sq, H, Dh), 0, 2, 1, 3)
        scores = torch.einsum("bhqd,bhkd->bhqk", q, k_cache) * (Dh ** -0.5)
        p = _softmax(scores, axis=-1)
        o = torch.einsum("bhqk,bhkd->bhqd", p, v_cache)
        return (lambda x, *d: x.permute(*d))(o, 0, 2, 1, 3).reshape(B, Sq, H * Dh) @ wo

    def _B_ref(x, w1, b1, w2):
        h = torch.einsum("bsd,df->bsf", x, w1) + b1
        sp = torch.log1p(torch.exp(-torch.abs(h))) + torch.where(h > 0, h, torch.zeros_like(h))
        act = h * torch.tanh(sp)
        return torch.einsum("bsf,fd->bsd", act, w2)

    x = A_x
    g = _sigmoid((x * gate_w).sum(-1, keepdims=True))
    a = _A_ref(x, A_k_cache, A_v_cache, A_wq, A_wo)
    b = _B_ref(x, B_w1, B_b1, B_w2)
    return g * a + (1 - g) * b
```

```asm
; @launch grid=(256,1,1) block=(256,1,1) lds=14592
.amdgcn_target "amdgcn-amd-amdhsa--gfx950"
.text
.p2align 12
.fill 192, 4, 0xbf810000
.globl gated_mix__mha_block_cached__dense_activation_mish__decode_kernel
.p2align 8
.type gated_mix__mha_block_cached__dense_activation_mish__decode_kernel,@function
gated_mix__mha_block_cached__dense_activation_mish__decode_kernel:
    s_cmp_ge_u32 s2, 256
    s_cbranch_scc1 L_end
    s_load_dwordx8 s[4:11], s[0:1], 0
    s_load_dwordx2 s[12:13], s[0:1], 32
    s_load_dwordx8 s[16:23], s[0:1], 48
    s_load_dwordx2 s[28:29], s[0:1], 96
    v_lshrrev_b32 v26, 4, v0
    v_lshrrev_b32 v24, 6, v0
    v_and_b32 v0, 63, v0
    v_readfirstlane_b32 s3, v24
    s_and_b32 s86, s2, 31
    s_lshr_b32 s87, s2, 7
    s_lshr_b32 s90, s2, 5
    v_and_b32 v25, 15, v0
    v_mov_b32 v15, 0x40000000
    s_mul_i32 s92, s90, 589824
    s_lshl_b32 s88, s86, 8
    s_add_u32 s92, s92, s88
    v_lshl_add_u32 v60, v25, 4, s92
    v_lshl_add_u32 v2, v26, 15, v60
    v_lshl_add_u32 v60, v26, 13, v60
    v_add_u32 v60, 524288, v60
    v_cmp_gt_u32 vcc, 8, v26
    s_nop 1
    v_cndmask_b32 v13, v15, v60, vcc
    v_bfe_u32 v60, v0, 3, 1
    v_mul_u32_u24 v61, 1152, v60
    s_mul_i32 s92, s90, 144
    v_add_u32 v60, s92, v61
    v_lshl_add_u32 v52, v26, 3, v60
    v_and_b32 v53, 7, v26
    v_lshl_add_u32 v53, v53, 1, v60
    s_mul_i32 s31, s2, 1821
    s_lshr_b32 s31, s31, 16
    s_mul_i32 s30, s31, 36
    s_sub_u32 s30, s2, s30
    s_mul_i32 s92, s31, 96
    v_mad_u32_u24 v26, v26, 6, s92
    s_lshl_b32 s92, s30, 8
    v_lshl_add_u32 v3, v25, 4, s92
    s_movk_i32 s92, 9216
    v_mad_u32_u24 v3, v26, s92, v3
    v_lshl_add_u32 v26, v26, 1, v61
    s_mov_b32 s42, 4718592
    s_mov_b32 s43, 0x20000
    s_mov_b32 s50, 5308416
    s_mov_b32 s51, 0x20000
    s_mov_b32 s58, 2304
    s_mov_b32 s59, 0x20000
    s_waitcnt lgkmcnt(0)
    s_mov_b64 s[40:41], s[10:11]
    s_mov_b64 s[56:57], s[4:5]
    s_movk_i32 s81, 0
    buffer_load_dwordx4 a[0:3], v2, s[40:43], s81 offen nt
    buffer_load_dwordx2 v[28:29], v52, s[56:59], 0 offen
    buffer_load_ushort v30, v53, s[56:59], 0 offen offset:128
    buffer_load_dwordx3 v[46:48], v26, s[56:59], 0 offen
    s_movk_i32 s81, 8192
    buffer_load_dwordx4 a[4:7], v2, s[40:43], s81 offen nt
    s_movk_i32 s81, 16384
    buffer_load_dwordx4 a[8:11], v2, s[40:43], s81 offen nt
    s_movk_i32 s81, 24576
    buffer_load_dwordx4 a[12:15], v2, s[40:43], s81 offen nt
    buffer_load_dwordx4 a[16:19], v13, s[40:43], 0 offen nt
    s_load_dword s95, s[28:29], 0xce000
    s_load_dwordx2 s[24:25], s[0:1], 80
    s_mov_b64 s[48:49], s[16:17]
    s_movk_i32 s81, 0
    buffer_load_dwordx4 a[20:23], v3, s[48:51], s81 offen nt
    s_movk_i32 s81, 9216
    buffer_load_dwordx4 a[24:27], v3, s[48:51], s81 offen nt
    s_movk_i32 s81, 18432
    buffer_load_dwordx4 a[28:31], v3, s[48:51], s81 offen nt
    s_waitcnt vmcnt(10)
    s_movk_i32 s81, 27648
    buffer_load_dwordx4 a[32:35], v3, s[48:51], s81 offen nt
    s_waitcnt vmcnt(7)
    s_mov_b32 s81, 36864
    buffer_load_dwordx4 a[36:39], v3, s[48:51], s81 offen nt
    s_waitcnt vmcnt(7)
    s_mov_b32 s81, 46080
    buffer_load_dwordx4 a[40:43], v3, s[48:51], s81 offen nt
    s_mov_b64 s[44:45], s[12:13]
    s_mov_b64 s[64:65], s[18:19]
    s_mov_b64 s[52:53], s[20:21]
    s_mov_b64 s[60:61], s[22:23]
    s_mov_b64 s[68:69], s[28:29]
    s_mov_b32 s46, 4718592
    s_mov_b32 s47, 0x20000
    s_mov_b32 s54, 5308416
    s_mov_b32 s55, 0x20000
    s_mov_b32 s34, 2097152
    s_mov_b32 s35, 0x20000
    s_mov_b32 s38, 2097152
    s_mov_b32 s39, 0x20000
    s_mov_b32 s62, 1152
    s_mov_b32 s63, 0x20000
    s_mov_b32 s66, 9216
    s_mov_b32 s67, 0x20000
    s_mov_b32 s70, 1110016
    s_mov_b32 s71, 0x20000
    s_mov_b32 s74, 2304
    s_mov_b32 s75, 0x20000
    s_and_b32 s88, s2, 7
    s_bfe_u32 s92, s2, 0x40003
    s_lshl4_add_u32 s88, s88, s92
    s_lshl1_add_u32 s92, s88, s87
    s_lshl2_add_u32 s92, s92, s3
    s_mulk_i32 s92, 5184
    v_lshl_add_u32 v51, v0, 7, s92
    v_cmp_gt_u32 vcc, 41, v0
    s_nop 1
    v_cndmask_b32 v51, v15, v51, vcc
    s_lshl3_add_u32 s26, s86, s90
    s_lshl2_add_u32 s92, s26, s3
    s_mulk_i32 s92, 4608
    v_lshl_add_u32 v50, v0, 7, s92
    v_cmp_gt_u32 vcc, 36, v0
    s_nop 1
    v_cndmask_b32 v50, v15, v50, vcc
    s_waitcnt vmcnt(7)
    buffer_load_dword v80, v51, s[52:55], 0 offen
    s_and_b32 s90, s90, 3
    s_lshl_b32 s91, s87, 5
    s_add_u32 s91, s91, s86
    s_lshl2_add_u32 s14, s91, s90
    s_lshl_b32 s15, s91, 21
    s_lshr_b32 s92, s90, 1
    s_lshl_b32 s92, s92, 8
    s_and_b32 s90, s90, 1
    s_lshl_b32 s90, s90, 4
    s_add_u32 s90, s90, s92
    s_add_u32 s90, s90, s3
    s_lshl_b32 s90, s90, 12
    v_lshl_add_u32 v1, v0, 4, s90
    s_add_u32 s32, s6, s15
    s_addc_u32 s33, s7, 0
    s_add_u32 s36, s8, s15
    s_addc_u32 s37, s9, 0
    s_mov_b32 s82, 0xcccccccc
    s_mov_b32 s83, 0xcccccccc
    s_mov_b32 s84, 0xaaaaaaaa
    s_mov_b32 s85, 0xaaaaaaaa
    s_mov_b32 s93, 0x01000100
    s_mov_b32 s94, 0x03020302
    s_mov_b32 s89, 0x3e0293ee
    v_mov_b32 v27, 0xffffff00
    v_and_b32 v26, 1, v0
    v_lshlrev_b32 v26, 4, v26
    v_mov_b32 v60, 0xffff
    v_lshlrev_b32 v26, v26, v60
    v_bfe_u32 v60, v0, 1, 2
    v_cmp_eq_u32 vcc, 0, v60
    s_nop 1
    v_cndmask_b32 v16, 0, v26, vcc
    v_cmp_eq_u32 vcc, 1, v60
    s_nop 1
    v_cndmask_b32 v17, 0, v26, vcc
    v_cmp_eq_u32 vcc, 2, v60
    s_nop 1
    v_cndmask_b32 v18, 0, v26, vcc
    v_cmp_eq_u32 vcc, 3, v60
    s_nop 1
    v_cndmask_b32 v19, 0, v26, vcc
    s_getpc_b64 s[4:5]
L_pc:
    s_lshr_b32 s90, s2, 3
    s_lshl2_add_u32 s90, s90, s3
    s_lshl_b32 s90, s90, 8
    v_and_b32 v54, 1, v0
    v_lshl_add_u32 v54, v54, 7, s90
    s_mov_b32 s90, L_end-L_pc
    v_min_u32 v54, s90, v54
    v_mov_b32 v55, s5
    v_add_co_u32 v54, vcc, s4, v54
    s_nop 1
    v_addc_co_u32 v55, vcc, 0, v55, vcc
    global_load_dword v81, v[54:55], off
    v_lshrrev_b32 v56, 3, v0
    v_and_b32 v57, 7, v0
    v_bfe_u32 v58, v0, 3, 1
    v_bfe_u32 v59, v0, 4, 1
    s_mulk_i32 s88, 36
    v_lshlrev_b32 v60, 4, v58
    v_mov_b32 v61, 0xffff
    v_lshlrev_b32 v60, v60, v61
    v_cmp_gt_u32 vcc, 4, v57
    s_nop 1
    v_cndmask_b32 v20, 0, v60, vcc
    v_xor_b32 v21, v20, v60
    v_and_b32 v60, 3, v0
    v_mul_u32_u24 v22, 0x5555, v60
    s_mul_i32 s90, s87, 18432
    s_lshl2_add_u32 s90, s88, s90
    s_add_u32 s90, s90, 0x98000
    v_mov_b32 v60, s90
    s_mov_b32 s91, 36864
    v_mad_u32_u24 v60, v57, s91, v60
    v_cmp_gt_u32 vcc, 6, v57
    s_nop 1
    v_cndmask_b32 v62, v15, v60, vcc
    v_and_b32 v60, 15, v0
    v_lshlrev_b32 v60, 5, v60
    v_lshl_add_u32 v60, v59, 4, v60
    s_lshl_b32 s90, s3, 9
    v_add_u32 v108, s90, v60
    v_lshrrev_b32 v61, 5, v0
    v_lshl_add_u32 v60, v61, 9, v108
    v_add_u32 v109, s90, v60
    v_xor_b32 v60, v61, v58
    v_lshl_add_u32 v60, v60, 3, v61
    v_lshl_add_u32 v60, v60, 8, s90
    v_lshl_add_u32 v60, v57, 5, v60
    v_lshl_add_u32 v111, v59, 4, v60
    v_mov_b32 v60, 0
    s_lshl_b32 s90, s3, 4
    v_mov_b32 v110, s90
    ds_write_b32 v110, v60 offset:8204
    ds_write_b32 v60, v60 offset:8256
    s_lshl_b32 s90, s14, 6
    s_add_u32 s90, s90, 0x90000
    v_lshl_add_u32 v60, v0, 4, s90
    s_lshl_b32 s90, s3, 6
    v_or_b32 v61, s90, v0
    v_cmp_gt_u32 vcc, 4, v61
    s_nop 1
    v_cndmask_b32 v63, v15, v60, vcc
    s_mul_i32 s90, s31, 36864
    s_lshl_b32 s91, s30, 9
    s_add_u32 s90, s90, s91
    s_add_u32 s90, s90, 0x98000
    s_lshl_b32 s91, s3, 8
    s_add_u32 s91, s91, s2
    s_cmp_lt_u32 s91, 216
    s_cselect_b32 s90, s90, 0x40000000
    s_lshl_b32 s92, s26, 10
    s_add_u32 s92, s92, 0xcf000
    s_movk_i32 s91, 18432
    s_cmp_eq_u32 s3, 1
    s_cselect_b32 s90, s92, s90
    s_cselect_b32 s91, 512, s91
    v_and_b32 v60, 31, v0
    v_lshl_add_u32 v60, v60, 4, s90
    v_lshrrev_b32 v61, 5, v0
    v_mad_u32_u24 v12, v61, s91, v60
    s_and_b32 s90, s3, 1
    s_lshl_b32 s90, s90, 12
    v_lshl_add_u32 v26, v0, 4, s90
    s_lshl_b32 s91, s3, 10
    s_sub_u32 s91, s90, s91
    v_add_u32 v60, s91, v109
    s_bitcmp1_b32 s3, 0
    s_cselect_b64 vcc, -1, 0
    v_cndmask_b32 v26, v26, v60, vcc
    s_waitcnt vmcnt(5)
    buffer_load_dword v80, v50, s[44:47], 0 offen
    v_perm_b32 v24, v28, v28, s93
    v_and_b32 v72, v24, v16
    v_and_b32 v73, v24, v17
    v_and_b32 v74, v24, v18
    v_and_b32 v75, v24, v19
    s_nop 1
    v_mfma_f32_16x16x32_bf16 v[68:71], v[72:75], a[0:3], 0
    v_perm_b32 v24, v28, v28, s94
    v_and_b32 v76, v24, v16
    v_and_b32 v77, v24, v17
    v_and_b32 v78, v24, v18
    v_and_b32 v79, v24, v19
    s_nop 1
    v_mfma_f32_16x16x32_bf16 v[68:71], v[76:79], a[4:7], v[68:71]
    v_perm_b32 v24, v29, v29, s93
    v_and_b32 v72, v24, v16
    v_and_b32 v73, v24, v17
    v_and_b32 v74, v24, v18
    v_and_b32 v75, v24, v19
    s_nop 1
    v_mfma_f32_16x16x32_bf16 v[68:71], v[72:75], a[8:11], v[68:71]
    v_perm_b32 v24, v29, v29, s94
    v_and_b32 v76, v24, v16
    v_and_b32 v77, v24, v17
    v_and_b32 v78, v24, v18
    v_and_b32 v79, v24, v19
    s_nop 1
    v_mfma_f32_16x16x32_bf16 v[68:71], v[76:79], a[12:15], v[68:71]
    v_perm_b32 v24, v30, v30, s93
    v_and_b32 v72, v24, v16
    v_and_b32 v73, v24, v17
    v_and_b32 v74, v24, v18
    v_and_b32 v75, v24, v19
    s_nop 1
    v_mfma_f32_16x16x32_bf16 v[68:71], v[72:75], a[16:19], v[68:71]
    v_perm_b32 v24, v46, v46, s93
    v_and_b32 v76, v24, v16
    v_and_b32 v77, v24, v17
    v_and_b32 v78, v24, v18
    v_and_b32 v79, v24, v19
    s_nop 1
    v_mfma_f32_16x16x32_bf16 v[96:99], v[76:79], a[20:23], 0
    v_perm_b32 v24, v46, v46, s94
    v_and_b32 v72, v24, v16
    v_and_b32 v73, v24, v17
    v_and_b32 v74, v24, v18
    v_and_b32 v75, v24, v19
    s_nop 1
    v_mfma_f32_16x16x32_bf16 v[96:99], v[72:75], a[24:27], v[96:99]
    v_perm_b32 v24, v47, v47, s93
    v_and_b32 v76, v24, v16
    v_and_b32 v77, v24, v17
    v_and_b32 v78, v24, v18
    v_and_b32 v79, v24, v19
    s_nop 1
    v_mfma_f32_16x16x32_bf16 v[96:99], v[76:79], a[28:31], v[96:99]
    s_movk_i32 s80, 0
    s_waitcnt vmcnt(2)
    buffer_load_dwordx4 v[112:115], v1, s[32:35], s80 offen offset:0 nt
    v_perm_b32 v24, v47, v47, s94
    v_and_b32 v72, v24, v16
    v_and_b32 v73, v24, v17
    v_and_b32 v74, v24, v18
    v_and_b32 v75, v24, v19
    s_nop 1
    v_mfma_f32_16x16x32_bf16 v[96:99], v[72:75], a[32:35], v[96:99]
    v_perm_b32 v24, v48, v48, s93
    v_and_b32 v76, v24, v16
    v_and_b32 v77, v24, v17
    v_and_b32 v78, v24, v18
    v_and_b32 v79, v24, v19
    s_nop 1
    v_mfma_f32_16x16x32_bf16 v[96:99], v[76:79], a[36:39], v[96:99]
    v_perm_b32 v24, v48, v48, s94
    v_and_b32 v72, v24, v16
    v_and_b32 v73, v24, v17
    v_and_b32 v74, v24, v18
    v_and_b32 v75, v24, v19
    s_nop 1
    v_mfma_f32_16x16x32_bf16 v[96:99], v[72:75], a[40:43], v[96:99]
    buffer_load_dwordx4 v[116:119], v1, s[32:35], s80 offen offset:1024 nt
    buffer_load_dwordx4 v[120:123], v1, s[32:35], s80 offen offset:2048 nt
    buffer_load_dwordx4 v[124:127], v1, s[32:35], s80 offen offset:3072 nt
    ds_write_b128 v109, v[68:71] offset:4096
    s_nop 3
    ds_write_b128 v109, v[96:99] offset:0
    s_waitcnt lgkmcnt(0)
    s_barrier
    ds_read_b128 v[96:99], v26 offset:0
    ds_read_b128 v[100:103], v26 offset:1024
    ds_read_b128 v[104:107], v26 offset:2048
    ds_read_b128 v[68:71], v26 offset:3072
    s_mov_b64 s[72:73], s[24:25]
    s_add_u32 s95, s95, 0x01010101
    s_bfe_u32 s76, s95, 0x80000
    s_bfe_u32 s77, s95, 0x80008
    s_bfe_u32 s78, s95, 0x80010
    s_bfe_u32 s79, s95, 0x80018
    s_waitcnt lgkmcnt(0)
    v_pk_add_f32 v[96:97], v[96:97], v[100:101]
    v_pk_add_f32 v[98:99], v[98:99], v[102:103]
    v_pk_add_f32 v[96:97], v[96:97], v[104:105]
    v_pk_add_f32 v[98:99], v[98:99], v[106:107]
    v_pk_add_f32 v[96:97], v[96:97], v[68:69]
    v_pk_add_f32 v[98:99], v[98:99], v[70:71]
    v_and_or_b32 v96, v96, v27, s76
    v_and_or_b32 v97, v97, v27, s77
    v_and_or_b32 v98, v98, v27, s78
    v_and_or_b32 v99, v99, v27, s79
    buffer_store_dwordx4 v[96:99], v12, s[68:71], 0 offen sc1
    s_movk_i32 s80, 16384
    s_waitcnt vmcnt(5)
    buffer_load_dwordx4 v[128:131], v1, s[32:35], s80 offen offset:0 nt
    buffer_load_dwordx4 v[132:135], v1, s[32:35], s80 offen offset:1024 nt
    s_and_b32 s90, s2, 7
    s_lshl_b32 s90, s90, 7
    s_add_u32 s90, s90, 0xce400
    v_and_b32 v60, 31, v0
    v_lshl_add_u32 v47, v60, 2, s90
    s_lshr_b32 s91, s2, 3
    s_lshl2_add_u32 s90, s91, s90
    v_mov_b32 v60, s90
    v_or_b32 v61, s3, v0
    v_cmp_eq_u32 vcc, 0, v61
    s_nop 1
    v_cndmask_b32 v46, v15, v60, vcc
    v_mov_b32 v45, s95
    s_mov_b32 s21, 0
    s_mov_b32 s23, 0
    v_lshlrev_b32 v54, 5, v0
    v_cmp_gt_u32 vcc, 36, v0
    s_nop 1
    v_cndmask_b32 v54, v15, v54, vcc
    s_mul_i32 s90, s87, 1152
    v_add_u32 v55, s90, v54
    buffer_load_dwordx4 v[80:83], v54, s[60:63], 0 offen
    buffer_load_dwordx4 v[84:87], v54, s[60:63], 0 offen offset:16
    buffer_load_dwordx4 v[88:91], v55, s[56:59], 0 offen
    buffer_load_dwordx4 v[92:95], v55, s[56:59], 0 offen offset:16
    s_waitcnt vmcnt(9)
    buffer_load_dwordx4 v[136:139], v1, s[32:35], s80 offen offset:2048 nt
    v_and_b32 v60, 3, v56
    v_and_or_b32 v60, v0, 32, v60
    s_mul_i32 s90, s86, 147456
    v_lshl_add_u32 v61, v57, 4, s90
    s_movk_i32 s91, 1152
    v_mad_u32_u24 v61, v60, s91, v61
    v_add_u32 v5, 1024, v61
    s_lshl_b32 s90, s3, 8
    v_add_u32 v4, s90, v61
    s_waitcnt vmcnt(9)
    buffer_load_dwordx4 v[140:143], v1, s[32:35], s80 offen offset:3072 nt
    s_mul_i32 s90, s88, 1152
    v_lshl_add_u32 v61, v57, 4, s90
    s_movk_i32 s91, 4608
    v_mad_u32_u24 v60, v56, s91, v61
    s_lshl_b32 s90, s3, 8
    v_add_u32 v6, s90, v60
    s_mul_i32 s92, s3, 1152
    s_addk_i32 s92, 1024
    v_add_u32 v8, s92, v60
    s_movk_i32 s91, 1152
    v_mad_u32_u24 v60, v56, s91, v61
    v_add_u32 v60, 36864, v60
    v_cmp_gt_u32 vcc, 32, v0
    s_nop 1
    v_cndmask_b32 v60, v15, v60, vcc
    v_add_u32 v7, s90, v60
    s_cmp_eq_u32 s3, 0
    s_cselect_b32 s90, 0, 0x40000000
    s_addk_i32 s90, 1024
    v_add_u32 v9, s90, v60
    s_mov_b32 s80, 32768
    s_waitcnt vmcnt(9)
    buffer_load_dwordx4 v[144:147], v1, s[32:35], s80 offen offset:0 nt
    s_mul_i32 s90, s14, 2304
    s_lshl_b32 s91, s3, 9
    s_add_u32 s91, s91, s90
    v_lshrrev_b32 v60, 5, v0
    v_lshl_add_u32 v60, v60, 8, s91
    v_lshl_add_u32 v60, v57, 5, v60
    v_lshl_add_u32 v60, v59, 4, v60
    v_cmp_eq_u32 vcc, 0, v58
    s_nop 1
    v_cndmask_b32 v10, v15, v60, vcc
    s_lshl_b32 s91, s3, 6
    s_add_u32 s91, s91, s90
    s_addk_i32 s91, 2048
    v_lshl_add_u32 v49, v57, 1, v59
    v_lshl_add_u32 v60, v49, 2, s91
    v_and_b32 v61, 40, v0
    v_cmp_eq_u32 vcc, 0, v61
    s_nop 1
    v_cndmask_b32 v11, v15, v60, vcc
    v_and_b32 v49, 3, v49
    v_lshlrev_b32 v49, 3, v49
    s_waitcnt vmcnt(8)
    buffer_load_dwordx4 v[148:151], v1, s[32:35], s80 offen offset:1024 nt
    v_lshl_add_u32 v60, v56, 2, s88
    v_lshlrev_b32 v60, 1, v60
    v_and_b32 v61, 3, v56
    v_add_lshl_u32 v61, v61, s88, 1
    buffer_load_dwordx2 v[42:43], v60, s[64:67], 0 offen
    buffer_load_ushort v44, v61, s[64:67], 0 offen offset:64
    v_lshrrev_b32 v49, v49, s95
    v_and_b32 v49, 0xff, v49
    s_lshl_b32 s90, s86, 13
    s_lshl_b32 s91, s87, 9
    s_add_u32 s90, s90, s91
    s_add_u32 s90, s90, 0xcf000
    v_and_b32 v60, 15, v0
    v_lshl_add_u32 v60, v60, 4, s90
    v_lshrrev_b32 v61, 4, v0
    v_lshl_add_u32 v2, v61, 11, v60
    s_waitcnt vmcnt(10)
    buffer_load_dwordx4 v[152:155], v1, s[32:35], s80 offen offset:2048 nt
    s_waitcnt vmcnt(6)
    buffer_load_dwordx4 v[156:159], v1, s[32:35], s80 offen offset:3072 nt
    v_dot2_f32_bf16 v12, v80, v88, 0
    v_dot2_f32_bf16 v12, v81, v89, v12
    v_dot2_f32_bf16 v12, v82, v90, v12
    v_dot2_f32_bf16 v12, v83, v91, v12
    v_dot2_f32_bf16 v12, v84, v92, v12
    v_dot2_f32_bf16 v12, v85, v93, v12
    v_dot2_f32_bf16 v12, v86, v94, v12
    v_dot2_f32_bf16 v12, v87, v95, v12
    s_nop 2
    v_add_f32_dpp v12, v12, v12 row_ror:8 row_mask:0xf bank_mask:0xf
    s_nop 1
    v_add_f32_dpp v12, v12, v12 row_ror:4 row_mask:0xf bank_mask:0xf
    s_nop 1
    v_add_f32_dpp v12, v12, v12 row_ror:2 row_mask:0xf bank_mask:0xf
    s_nop 1
    v_add_f32_dpp v12, v12, v12 row_ror:1 row_mask:0xf bank_mask:0xf
    v_mov_b32 v60, v12
    s_nop 1
    v_permlane16_swap_b32 v12, v60
    v_add_f32 v12, v12, v60
    v_mov_b32 v60, v12
    s_nop 1
    v_permlane32_swap_b32 v12, v60
    v_add_f32 v12, v12, v60
    v_mul_f32 v12, 0xbfb8aa3b, v12
    v_exp_f32 v12, v12
    s_nop 0
    v_add_f32 v12, 1.0, v12
    v_rcp_f32 v12, v12
    s_mov_b32 s80, 49152
    s_waitcnt vmcnt(6)
    buffer_load_dwordx4 v[160:163], v1, s[32:35], s80 offen offset:0 nt
    s_waitcnt vmcnt(6)
    buffer_load_dwordx4 v[164:167], v1, s[32:35], s80 offen offset:1024 nt
    buffer_load_dwordx4 v[168:171], v2, s[68:71], 0 offen offset:0
    buffer_load_dwordx4 v[172:175], v2, s[68:71], 0 offen offset:256
    buffer_load_dwordx4 v[176:179], v2, s[68:71], 0 offen offset:1024
    buffer_load_dwordx4 v[180:183], v2, s[68:71], 0 offen offset:1280
    s_waitcnt vmcnt(10)
    buffer_load_dwordx4 v[184:187], v1, s[32:35], s80 offen offset:2048 nt
    s_waitcnt vmcnt(8)
    buffer_load_dwordx4 v[188:191], v1, s[32:35], s80 offen offset:3072 nt
    v_add_u32 v45, 1, v45
    buffer_store_dword v45, v46, s[68:71], 0 offen
    buffer_load_dword v48, v47, s[68:71], 0 offen nt
    s_mov_b32 s80, 131072
    s_waitcnt vmcnt(10)
    buffer_load_dwordx4 v[192:195], v1, s[32:35], s80 offen offset:0 nt
    s_waitcnt vmcnt(10)
    buffer_load_dwordx4 v[196:199], v1, s[32:35], s80 offen offset:1024 nt
    s_waitcnt vmcnt(10)
    buffer_load_dwordx4 v[200:203], v1, s[32:35], s80 offen offset:2048 nt
    s_waitcnt vmcnt(6)
    buffer_load_dwordx4 v[204:207], v1, s[32:35], s80 offen offset:3072 nt
    s_mov_b32 s92, 0x40000
L_q:
    v_xor_b32 v80, s76, v168
    v_xor_b32 v81, s77, v169
    v_xor_b32 v82, s78, v170
    v_xor_b32 v83, s79, v171
    v_xor_b32 v84, s76, v172
    v_xor_b32 v85, s77, v173
    v_xor_b32 v86, s78, v174
    v_xor_b32 v87, s79, v175
    v_xor_b32 v88, s76, v176
    v_xor_b32 v89, s77, v177
    v_xor_b32 v90, s78, v178
    v_xor_b32 v91, s79, v179
    v_xor_b32 v92, s76, v180
    v_xor_b32 v93, s77, v181
    v_xor_b32 v94, s78, v182
    v_xor_b32 v95, s79, v183
    v_or3_b32 v24, v80, v81, v82
    v_or3_b32 v24, v24, v83, v84
    v_or3_b32 v24, v24, v85, v86
    v_or3_b32 v24, v24, v87, v88
    v_or3_b32 v24, v24, v89, v90
    v_or3_b32 v24, v24, v91, v92
    v_or3_b32 v24, v24, v93, v94
    v_or_b32 v24, v24, v95
    v_and_b32 v24, 0xff, v24
    v_cmp_ne_u32 vcc, 0, v24
    s_cbranch_vccz L_q_ok
    s_sub_u32 s92, s92, 1
    s_cbranch_scc1 L_q_ok
    s_sleep 1
    buffer_load_dwordx4 v[168:171], v2, s[68:71], 0 offen offset:0 sc1
    buffer_load_dwordx4 v[172:175], v2, s[68:71], 0 offen offset:256 sc1
    buffer_load_dwordx4 v[176:179], v2, s[68:71], 0 offen offset:1024 sc1
    buffer_load_dwordx4 v[180:183], v2, s[68:71], 0 offen offset:1280 sc1
    s_waitcnt vmcnt(0)
    s_branch L_q
L_q_ok:
    s_mov_b32 s80, 147456
    s_waitcnt vmcnt(6)
    buffer_load_dwordx4 v[208:211], v1, s[32:35], s80 offen offset:0 nt
    v_pk_add_f32 v[80:81], v[80:81], v[88:89]
    v_pk_add_f32 v[82:83], v[82:83], v[90:91]
    v_pk_add_f32 v[84:85], v[84:85], v[92:93]
    v_pk_add_f32 v[86:87], v[86:87], v[94:95]
    s_nop 0
    v_permlane32_swap_b32 v80, v84
    v_permlane32_swap_b32 v81, v85
    v_permlane32_swap_b32 v82, v86
    v_permlane32_swap_b32 v83, v87
    v_add_f32 v80, v80, v84
    v_add_f32 v81, v81, v85
    v_add_f32 v82, v82, v86
    v_add_f32 v83, v83, v87
    s_nop 0
    v_permlane16_swap_b32 v80, v82
    v_permlane16_swap_b32 v81, v83
    v_add_f32 v80, v80, v82
    v_add_f32 v81, v81, v83
    v_cvt_pk_bf16_f32 v64, v80, v81
    v_cvt_pk_bf16_f32 v65, v80, v81
    s_nop 1
    v_permlane16_swap_b32 v64, v65
    v_mov_b32 v66, v64
    v_mov_b32 v67, v65
    s_nop 0
    v_permlane32_swap_b32 v64, v66
    v_permlane32_swap_b32 v65, v67
    s_waitcnt vmcnt(4)
    buffer_load_dwordx4 v[212:215], v1, s[32:35], s80 offen offset:1024 nt
    v_sub_u32 v48, v48, v45
    v_cmp_gt_u32 vcc, 64, v48
    s_nop 0
    s_bcnt1_i32_b64 s27, vcc
    s_add_u32 s27, s27, s23
    s_max_i32 s27, s27, 0
    v_dot2_f32_bf16 v50, v112, v64, 0
    v_dot2_f32_bf16 v51, v116, v64, 0
    v_dot2_f32_bf16 v52, v120, v64, 0
    v_dot2_f32_bf16 v53, v124, v64, 0
    v_dot2_f32_bf16 v50, v113, v65, v50
    v_dot2_f32_bf16 v51, v117, v65, v51
    v_dot2_f32_bf16 v52, v121, v65, v52
    v_dot2_f32_bf16 v53, v125, v65, v53
    v_dot2_f32_bf16 v50, v114, v66, v50
    v_dot2_f32_bf16 v51, v118, v66, v51
    v_dot2_f32_bf16 v52, v122, v66, v52
    v_dot2_f32_bf16 v53, v126, v66, v53
    v_dot2_f32_bf16 v50, v115, v67, v50
    v_dot2_f32_bf16 v51, v119, v67, v51
    v_dot2_f32_bf16 v52, v123, v67, v52
    v_dot2_f32_bf16 v53, v127, v67, v53
    v_add_f32_dpp v54, v50, v50 row_ror:8 row_mask:0xf bank_mask:0x3
    v_add_f32_dpp v55, v51, v51 row_ror:8 row_mask:0xf bank_mask:0x3
    s_nop 0
    v_add_f32_dpp v54, v52, v52 row_ror:8 row_mask:0xf bank_mask:0xc
    v_add_f32_dpp v55, v53, v53 row_ror:8 row_mask:0xf bank_mask:0xc
    s_nop 0
    v_add_f32_dpp v56, v54, v54 row_half_mirror row_mask:0xf bank_mask:0x5
    s_nop 1
    v_add_f32_dpp v56, v55, v55 row_half_mirror row_mask:0xf bank_mask:0xa
    s_cmp_ge_u32 s27, 36
    s_cbranch_scc1 L_f22
    s_waitcnt vmcnt(4)
L_f22:
    buffer_load_dwordx4 v[216:219], v1, s[32:35], s80 offen offset:2048 nt
    v_dot2_f32_bf16 v50, v128, v64, 0
    v_dot2_f32_bf16 v51, v132, v64, 0
    v_dot2_f32_bf16 v52, v136, v64, 0
    v_dot2_f32_bf16 v53, v140, v64, 0
    v_dot2_f32_bf16 v50, v129, v65, v50
    v_dot2_f32_bf16 v51, v133, v65, v51
    v_dot2_f32_bf16 v52, v137, v65, v52
    v_dot2_f32_bf16 v53, v141, v65, v53
    v_dot2_f32_bf16 v50, v130, v66, v50
    v_dot2_f32_bf16 v51, v134, v66, v51
    v_dot2_f32_bf16 v52, v138, v66, v52
    v_dot2_f32_bf16 v53, v142, v66, v53
    v_dot2_f32_bf16 v50, v131, v67, v50
    v_dot2_f32_bf16 v51, v135, v67, v51
    v_dot2_f32_bf16 v52, v139, v67, v52
    v_dot2_f32_bf16 v53, v143, v67, v53
    v_add_f32_dpp v54, v50, v50 row_ror:8 row_mask:0xf bank_mask:0x3
    v_add_f32_dpp v55, v51, v51 row_ror:8 row_mask:0xf bank_mask:0x3
    s_nop 0
    v_add_f32_dpp v54, v52, v52 row_ror:8 row_mask:0xf bank_mask:0xc
    v_add_f32_dpp v55, v53, v53 row_ror:8 row_mask:0xf bank_mask:0xc
    s_nop 0
    v_add_f32_dpp v57, v54, v54 row_half_mirror row_mask:0xf bank_mask:0x5
    s_nop 1
    v_add_f32_dpp v57, v55, v55 row_half_mirror row_mask:0xf bank_mask:0xa
    s_cmp_ge_u32 s27, 39
    s_cbranch_scc1 L_f23
    s_waitcnt vmcnt(4)
L_f23:
    buffer_load_dwordx4 v[220:223], v1, s[32:35], s80 offen offset:3072 nt
    v_dot2_f32_bf16 v50, v144, v64, 0
    v_dot2_f32_bf16 v51, v148, v64, 0
    v_dot2_f32_bf16 v52, v152, v64, 0
    v_dot2_f32_bf16 v53, v156, v64, 0
    v_dot2_f32_bf16 v50, v145, v65, v50
    v_dot2_f32_bf16 v51, v149, v65, v51
    v_dot2_f32_bf16 v52, v153, v65, v52
    v_dot2_f32_bf16 v53, v157, v65, v53
    v_dot2_f32_bf16 v50, v146, v66, v50
    v_dot2_f32_bf16 v51, v150, v66, v51
    v_dot2_f32_bf16 v52, v154, v66, v52
    v_dot2_f32_bf16 v53, v158, v66, v53
    v_dot2_f32_bf16 v50, v147, v67, v50
    v_dot2_f32_bf16 v51, v151, v67, v51
    v_dot2_f32_bf16 v52, v155, v67, v52
    v_dot2_f32_bf16 v53, v159, v67, v53
    v_add_f32_dpp v54, v50, v50 row_ror:8 row_mask:0xf bank_mask:0x3
    v_add_f32_dpp v55, v51, v51 row_ror:8 row_mask:0xf bank_mask:0x3
    s_nop 0
    v_add_f32_dpp v54, v52, v52 row_ror:8 row_mask:0xf bank_mask:0xc
    v_add_f32_dpp v55, v53, v53 row_ror:8 row_mask:0xf bank_mask:0xc
    s_nop 0
    v_add_f32_dpp v58, v54, v54 row_half_mirror row_mask:0xf bank_mask:0x5
    s_nop 1
    v_add_f32_dpp v58, v55, v55 row_half_mirror row_mask:0xf bank_mask:0xa
    s_mov_b32 s80, 163840
    s_waitcnt vmcnt(6)
    s_cmp_ge_u32 s27, 43
    s_cbranch_scc1 L_f24
    s_waitcnt vmcnt(4)
L_f24:
    buffer_load_dwordx4 v[224:227], v1, s[32:35], s80 offen offset:0 nt
    v_dot2_f32_bf16 v50, v160, v64, 0
    v_dot2_f32_bf16 v51, v164, v64, 0
    v_dot2_f32_bf16 v52, v184, v64, 0
    v_dot2_f32_bf16 v53, v188, v64, 0
    v_dot2_f32_bf16 v50, v161, v65, v50
    v_dot2_f32_bf16 v51, v165, v65, v51
    v_dot2_f32_bf16 v52, v185, v65, v52
    v_dot2_f32_bf16 v53, v189, v65, v53
    v_dot2_f32_bf16 v50, v162, v66, v50
    v_dot2_f32_bf16 v51, v166, v66, v51
    v_dot2_f32_bf16 v52, v186, v66, v52
    v_dot2_f32_bf16 v53, v190, v66, v53
    v_dot2_f32_bf16 v50, v163, v67, v50
    v_dot2_f32_bf16 v51, v167, v67, v51
    v_dot2_f32_bf16 v52, v187, v67, v52
    v_dot2_f32_bf16 v53, v191, v67, v53
    v_add_f32_dpp v54, v50, v50 row_ror:8 row_mask:0xf bank_mask:0x3
    v_add_f32_dpp v55, v51, v51 row_ror:8 row_mask:0xf bank_mask:0x3
    s_nop 0
    v_add_f32_dpp v54, v52, v52 row_ror:8 row_mask:0xf bank_mask:0xc
    v_add_f32_dpp v55, v53, v53 row_ror:8 row_mask:0xf bank_mask:0xc
    s_nop 0
    v_add_f32_dpp v59, v54, v54 row_half_mirror row_mask:0xf bank_mask:0x5
    s_nop 1
    v_add_f32_dpp v59, v55, v55 row_half_mirror row_mask:0xf bank_mask:0xa
    v_cndmask_b32 v50, v56, v58, s[82:83]
    v_cndmask_b32 v51, v58, v56, s[82:83]
    v_cndmask_b32 v52, v57, v59, s[82:83]
    v_cndmask_b32 v53, v59, v57, s[82:83]
    v_add_f32_dpp v54, v51, v50 quad_perm:[2,3,0,1] row_mask:0xf bank_mask:0xf
    s_nop 0
    v_add_f32_dpp v55, v53, v52 quad_perm:[2,3,0,1] row_mask:0xf bank_mask:0xf
    v_cndmask_b32 v60, v54, v55, s[84:85]
    v_cndmask_b32 v61, v55, v54, s[84:85]
    s_nop 1
    v_add_f32_dpp v28, v61, v60 quad_perm:[1,0,3,2] row_mask:0xf bank_mask:0xf
    s_waitcnt vmcnt(6)
    s_cmp_ge_u32 s27, 46
    s_cbranch_scc1 L_f25
    s_waitcnt vmcnt(4)
L_f25:
    buffer_load_dwordx4 v[228:231], v1, s[32:35], s80 offen offset:1024 nt
    s_waitcnt vmcnt(6)
    s_cmp_ge_u32 s27, 49
    s_cbranch_scc1 L_f26
    s_waitcnt vmcnt(4)
L_f26:
    buffer_load_dwordx4 v[232:235], v1, s[32:35], s80 offen offset:2048 nt
    v_dot2_f32_bf16 v50, v192, v64, 0
    v_dot2_f32_bf16 v51, v196, v64, 0
    v_dot2_f32_bf16 v52, v200, v64, 0
    v_dot2_f32_bf16 v53, v204, v64, 0
    v_dot2_f32_bf16 v50, v193, v65, v50
    v_dot2_f32_bf16 v51, v197, v65, v51
    v_dot2_f32_bf16 v52, v201, v65, v52
    v_dot2_f32_bf16 v53, v205, v65, v53
    v_dot2_f32_bf16 v50, v194, v66, v50
    v_dot2_f32_bf16 v51, v198, v66, v51
    v_dot2_f32_bf16 v52, v202, v66, v52
    v_dot2_f32_bf16 v53, v206, v66, v53
    v_dot2_f32_bf16 v50, v195, v67, v50
    v_dot2_f32_bf16 v51, v199, v67, v51
    v_dot2_f32_bf16 v52, v203, v67, v52
    v_dot2_f32_bf16 v53, v207, v67, v53
    v_add_f32_dpp v54, v50, v50 row_ror:8 row_mask:0xf bank_mask:0x3
    v_add_f32_dpp v55, v51, v51 row_ror:8 row_mask:0xf bank_mask:0x3
    s_nop 0
    v_add_f32_dpp v54, v52, v52 row_ror:8 row_mask:0xf bank_mask:0xc
    v_add_f32_dpp v55, v53, v53 row_ror:8 row_mask:0xf bank_mask:0xc
    s_nop 0
    v_add_f32_dpp v56, v54, v54 row_half_mirror row_mask:0xf bank_mask:0x5
    s_nop 1
    v_add_f32_dpp v56, v55, v55 row_half_mirror row_mask:0xf bank_mask:0xa
    s_waitcnt vmcnt(6)
    s_cmp_ge_u32 s27, 52
    s_cbranch_scc1 L_f27
    s_waitcnt vmcnt(4)
L_f27:
    buffer_load_dwordx4 v[236:239], v1, s[32:35], s80 offen offset:3072 nt
    v_add_u32 v45, 1, v45
    buffer_store_dword v45, v46, s[68:71], 0 offen
    buffer_load_dword v48, v47, s[68:71], 0 offen nt
    s_mov_b32 s80, 180224
    s_waitcnt vmcnt(8)
    s_cmp_ge_u32 s27, 56
    s_cbranch_scc1 L_f28
    s_waitcnt vmcnt(6)
L_f28:
    buffer_load_dwordx4 v[240:243], v1, s[32:35], s80 offen offset:0 nt
    s_lshl1_add_u32 s81, s3, 0
    s_and_b32 s81, s81, 7
    s_mulk_i32 s81, 4608
    buffer_load_dwordx4 a[112:115], v4, s[44:47], s81 offen offset:0
    s_waitcnt vmcnt(9)
    s_cmp_ge_u32 s27, 59
    s_cbranch_scc1 L_f29
    s_waitcnt vmcnt(7)
L_f29:
    buffer_load_dwordx4 v[244:247], v1, s[32:35], s80 offen offset:1024 nt
    s_waitcnt vmcnt(9)
    s_cmp_ge_u32 s27, 62
    s_cbranch_scc1 L_f30
    s_waitcnt vmcnt(7)
L_f30:
    buffer_load_dwordx4 v[248:251], v1, s[32:35], s80 offen offset:2048 nt
    v_dot2_f32_bf16 v50, v208, v64, 0
    v_dot2_f32_bf16 v51, v212, v64, 0
    v_dot2_f32_bf16 v52, v216, v64, 0
    v_dot2_f32_bf16 v53, v220, v64, 0
    v_dot2_f32_bf16 v50, v209, v65, v50
    v_dot2_f32_bf16 v51, v213, v65, v51
    v_dot2_f32_bf16 v52, v217, v65, v52
    v_dot2_f32_bf16 v53, v221, v65, v53
    v_dot2_f32_bf16 v50, v210, v66, v50
    v_dot2_f32_bf16 v51, v214, v66, v51
    v_dot2_f32_bf16 v52, v218, v66, v52
    v_dot2_f32_bf16 v53, v222, v66, v53
    v_dot2_f32_bf16 v50, v211, v67, v50
    v_dot2_f32_bf16 v51, v215, v67, v51
    v_dot2_f32_bf16 v52, v219, v67, v52
    v_dot2_f32_bf16 v53, v223, v67, v53
    v_add_f32_dpp v54, v50, v50 row_ror:8 row_mask:0xf bank_mask:0x3
    v_add_f32_dpp v55, v51, v51 row_ror:8 row_mask:0xf bank_mask:0x3
    s_nop 0
    v_add_f32_dpp v54, v52, v52 row_ror:8 row_mask:0xf bank_mask:0xc
    v_add_f32_dpp v55, v53, v53 row_ror:8 row_mask:0xf bank_mask:0xc
    s_nop 0
    v_add_f32_dpp v57, v54, v54 row_half_mirror row_mask:0xf bank_mask:0x5
    s_nop 1
    v_add_f32_dpp v57, v55, v55 row_half_mirror row_mask:0xf bank_mask:0xa
    s_waitcnt vmcnt(9)
    s_cmp_ge_u32 s27, 66
    s_cbranch_scc1 L_f31
    s_waitcnt vmcnt(7)
L_f31:
    buffer_load_dwordx4 v[252:255], v1, s[32:35], s80 offen offset:3072 nt
    s_mov_b32 s80, 262144
    s_waitcnt vmcnt(9)
    s_cmp_ge_u32 s27, 69
    s_cbranch_scc1 L_f32
    s_waitcnt vmcnt(7)
L_f32:
    buffer_load_dwordx4 v[168:171], v1, s[32:35], s80 offen offset:0 nt
    s_waitcnt vmcnt(9)
    s_cmp_ge_u32 s27, 72
    s_cbranch_scc1 L_f33
    s_waitcnt vmcnt(5)
L_f33:
    buffer_load_dwordx4 v[172:175], v1, s[32:35], s80 offen offset:1024 nt
    buffer_load_dwordx4 a[120:123], v4, s[44:47], s81 offen offset:128
    s_waitcnt vmcnt(10)
    s_cmp_ge_u32 s27, 76
    s_cbranch_scc1 L_f34
    s_waitcnt vmcnt(5)
L_f34:
    buffer_load_dwordx4 v[176:179], v1, s[32:35], s80 offen offset:2048 nt
    v_dot2_f32_bf16 v50, v224, v64, 0
    v_dot2_f32_bf16 v51, v228, v64, 0
    v_dot2_f32_bf16 v52, v232, v64, 0
    v_dot2_f32_bf16 v53, v236, v64, 0
    v_dot2_f32_bf16 v50, v225, v65, v50
    v_dot2_f32_bf16 v51, v229, v65, v51
    v_dot2_f32_bf16 v52, v233, v65, v52
    v_dot2_f32_bf16 v53, v237, v65, v53
    v_dot2_f32_bf16 v50, v226, v66, v50
    v_dot2_f32_bf16 v51, v230, v66, v51
    v_dot2_f32_bf16 v52, v234, v66, v52
    v_dot2_f32_bf16 v53, v238, v66, v53
    v_dot2_f32_bf16 v50, v227, v67, v50
    v_dot2_f32_bf16 v51, v231, v67, v51
    v_dot2_f32_bf16 v52, v235, v67, v52
    v_dot2_f32_bf16 v53, v239, v67, v53
    v_add_f32_dpp v54, v50, v50 row_ror:8 row_mask:0xf bank_mask:0x3
    v_add_f32_dpp v55, v51, v51 row_ror:8 row_mask:0xf bank_mask:0x3
    s_nop 0
    v_add_f32_dpp v54, v52, v52 row_ror:8 row_mask:0xf bank_mask:0xc
    v_add_f32_dpp v55, v53, v53 row_ror:8 row_mask:0xf bank_mask:0xc
    s_nop 0
    v_add_f32_dpp v58, v54, v54 row_half_mirror row_mask:0xf bank_mask:0x5
    s_nop 1
    v_add_f32_dpp v58, v55, v55 row_half_mirror row_mask:0xf bank_mask:0xa
    s_waitcnt vmcnt(8)
    s_cmp_ge_u32 s27, 79
    s_cbranch_scc1 L_f35
    s_waitcnt vmcnt(5)
L_f35:
    buffer_load_dwordx4 v[180:183], v1, s[32:35], s80 offen offset:3072 nt
    v_sub_u32 v48, v48, v45
    v_cmp_gt_u32 vcc, 64, v48
    s_nop 0
    s_bcnt1_i32_b64 s27, vcc
    s_add_u32 s27, s27, s23
    s_max_i32 s27, s27, 0
    s_mov_b32 s80, 278528
    s_waitcnt vmcnt(7)
    s_cmp_ge_u32 s27, 36
    s_cbranch_scc1 L_f36
    s_waitcnt vmcnt(5)
L_f36:
    buffer_load_dwordx4 v[112:115], v1, s[32:35], s80 offen offset:0 nt
    s_waitcnt vmcnt(7)
    s_cmp_ge_u32 s27, 39
    s_cbranch_scc1 L_f37
    s_waitcnt vmcnt(5)
L_f37:
    buffer_load_dwordx4 v[116:119], v1, s[32:35], s80 offen offset:1024 nt
    buffer_load_dwordx4 a[240:243], v5, s[44:47], s81 offen offset:0
    s_waitcnt vmcnt(8)
    s_cmp_ge_u32 s27, 43
    s_cbranch_scc1 L_f38
    s_waitcnt vmcnt(6)
L_f38:
    buffer_load_dwordx4 v[120:123], v1, s[32:35], s80 offen offset:2048 nt
    v_dot2_f32_bf16 v50, v240, v64, 0
    v_dot2_f32_bf16 v51, v244, v64, 0
    v_dot2_f32_bf16 v52, v248, v64, 0
    v_dot2_f32_bf16 v53, v252, v64, 0
    v_dot2_f32_bf16 v50, v241, v65, v50
    v_dot2_f32_bf16 v51, v245, v65, v51
    v_dot2_f32_bf16 v52, v249, v65, v52
    v_dot2_f32_bf16 v53, v253, v65, v53
    v_dot2_f32_bf16 v50, v242, v66, v50
    v_dot2_f32_bf16 v51, v246, v66, v51
    v_dot2_f32_bf16 v52, v250, v66, v52
    v_dot2_f32_bf16 v53, v254, v66, v53
    v_dot2_f32_bf16 v50, v243, v67, v50
    v_dot2_f32_bf16 v51, v247, v67, v51
    v_dot2_f32_bf16 v52, v251, v67, v52
    v_dot2_f32_bf16 v53, v255, v67, v53
    v_add_f32_dpp v54, v50, v50 row_ror:8 row_mask:0xf bank_mask:0x3
    v_add_f32_dpp v55, v51, v51 row_ror:8 row_mask:0xf bank_mask:0x3
    s_nop 0
    v_add_f32_dpp v54, v52, v52 row_ror:8 row_mask:0xf bank_mask:0xc
    v_add_f32_dpp v55, v53, v53 row_ror:8 row_mask:0xf bank_mask:0xc
    s_nop 0
    v_add_f32_dpp v59, v54, v54 row_half_mirror row_mask:0xf bank_mask:0x5
    s_nop 1
    v_add_f32_dpp v59, v55, v55 row_half_mirror row_mask:0xf bank_mask:0xa
    v_cndmask_b32 v50, v56, v58, s[82:83]
    v_cndmask_b32 v51, v58, v56, s[82:83]
    v_cndmask_b32 v52, v57, v59, s[82:83]
    v_cndmask_b32 v53, v59, v57, s[82:83]
    v_add_f32_dpp v54, v51, v50 quad_perm:[2,3,0,1] row_mask:0xf bank_mask:0xf
    s_nop 0
    v_add_f32_dpp v55, v53, v52 quad_perm:[2,3,0,1] row_mask:0xf bank_mask:0xf
    v_cndmask_b32 v60, v54, v55, s[84:85]
    v_cndmask_b32 v61, v55, v54, s[84:85]
    s_nop 1
    v_add_f32_dpp v29, v61, v60 quad_perm:[1,0,3,2] row_mask:0xf bank_mask:0xf
    s_waitcnt vmcnt(8)
    s_cmp_ge_u32 s27, 46
    s_cbranch_scc1 L_f39
    s_waitcnt vmcnt(5)
L_f39:
    buffer_load_dwordx4 v[124:127], v1, s[32:35], s80 offen offset:3072 nt
    v_add_u32 v45, 1, v45
    buffer_store_dword v45, v46, s[68:71], 0 offen
    buffer_load_dword v48, v47, s[68:71], 0 offen nt
    s_mov_b32 s80, 294912
    s_waitcnt vmcnt(10)
    s_cmp_ge_u32 s27, 49
    s_cbranch_scc1 L_f40
    s_waitcnt vmcnt(7)
L_f40:
    buffer_load_dwordx4 v[128:131], v1, s[32:35], s80 offen offset:0 nt
    s_waitcnt vmcnt(9)
    s_cmp_ge_u32 s27, 52
    s_cbranch_scc1 L_f41
    s_waitcnt vmcnt(7)
L_f41:
    buffer_load_dwordx4 v[132:135], v1, s[32:35], s80 offen offset:1024 nt
    s_waitcnt vmcnt(9)
    s_cmp_ge_u32 s27, 56
    s_cbranch_scc1 L_f42
    s_waitcnt vmcnt(7)
L_f42:
    buffer_load_dwordx4 v[136:139], v1, s[32:35], s80 offen offset:2048 nt
    v_dot2_f32_bf16 v50, v168, v64, 0
    v_dot2_f32_bf16 v51, v172, v64, 0
    v_dot2_f32_bf16 v52, v176, v64, 0
    v_dot2_f32_bf16 v53, v180, v64, 0
    v_dot2_f32_bf16 v50, v169, v65, v50
    v_dot2_f32_bf16 v51, v173, v65, v51
    v_dot2_f32_bf16 v52, v177, v65, v52
    v_dot2_f32_bf16 v53, v181, v65, v53
    v_dot2_f32_bf16 v50, v170, v66, v50
    v_dot2_f32_bf16 v51, v174, v66, v51
    v_dot2_f32_bf16 v52, v178, v66, v52
    v_dot2_f32_bf16 v53, v182, v66, v53
    v_dot2_f32_bf16 v50, v171, v67, v50
    v_dot2_f32_bf16 v51, v175, v67, v51
    v_dot2_f32_bf16 v52, v179, v67, v52
    v_dot2_f32_bf16 v53, v183, v67, v53
    v_add_f32_dpp v54, v50, v50 row_ror:8 row_mask:0xf bank_mask:0x3
    v_add_f32_dpp v55, v51, v51 row_ror:8 row_mask:0xf bank_mask:0x3
    s_nop 0
    v_add_f32_dpp v54, v52, v52 row_ror:8 row_mask:0xf bank_mask:0xc
    v_add_f32_dpp v55, v53, v53 row_ror:8 row_mask:0xf bank_mask:0xc
    s_nop 0
    v_add_f32_dpp v56, v54, v54 row_half_mirror row_mask:0xf bank_mask:0x5
    s_nop 1
    v_add_f32_dpp v56, v55, v55 row_half_mirror row_mask:0xf bank_mask:0xa
    s_add_u32 s81, s81, 73728
    buffer_load_dwordx4 a[116:119], v4, s[44:47], s81 offen offset:0
    s_waitcnt vmcnt(10)
    s_cmp_ge_u32 s27, 59
    s_cbranch_scc1 L_f43
    s_waitcnt vmcnt(7)
L_f43:
    buffer_load_dwordx4 v[140:143], v1, s[32:35], s80 offen offset:3072 nt
    s_mov_b32 s80, 311296
    s_waitcnt vmcnt(10)
    s_cmp_ge_u32 s27, 62
    s_cbranch_scc1 L_f44
    s_waitcnt vmcnt(7)
L_f44:
    buffer_load_dwordx4 v[144:147], v1, s[32:35], s80 offen offset:0 nt
    s_waitcnt vmcnt(9)
    s_cmp_ge_u32 s27, 66
    s_cbranch_scc1 L_f45
    s_waitcnt vmcnt(5)
L_f45:
    buffer_load_dwordx4 v[148:151], v1, s[32:35], s80 offen offset:1024 nt
    s_waitcnt vmcnt(9)
    s_cmp_ge_u32 s27, 69
    s_cbranch_scc1 L_f46
    s_waitcnt vmcnt(5)
L_f46:
    buffer_load_dwordx4 v[152:155], v1, s[32:35], s80 offen offset:2048 nt
    v_dot2_f32_bf16 v50, v112, v64, 0
    v_dot2_f32_bf16 v51, v116, v64, 0
    v_dot2_f32_bf16 v52, v120, v64, 0
    v_dot2_f32_bf16 v53, v124, v64, 0
    v_dot2_f32_bf16 v50, v113, v65, v50
    v_dot2_f32_bf16 v51, v117, v65, v51
    v_dot2_f32_bf16 v52, v121, v65, v52
    v_dot2_f32_bf16 v53, v125, v65, v53
    v_dot2_f32_bf16 v50, v114, v66, v50
    v_dot2_f32_bf16 v51, v118, v66, v51
    v_dot2_f32_bf16 v52, v122, v66, v52
    v_dot2_f32_bf16 v53, v126, v66, v53
    v_dot2_f32_bf16 v50, v115, v67, v50
    v_dot2_f32_bf16 v51, v119, v67, v51
    v_dot2_f32_bf16 v52, v123, v67, v52
    v_dot2_f32_bf16 v53, v127, v67, v53
    v_add_f32_dpp v54, v50, v50 row_ror:8 row_mask:0xf bank_mask:0x3
    v_add_f32_dpp v55, v51, v51 row_ror:8 row_mask:0xf bank_mask:0x3
    s_nop 0
    v_add_f32_dpp v54, v52, v52 row_ror:8 row_mask:0xf bank_mask:0xc
    v_add_f32_dpp v55, v53, v53 row_ror:8 row_mask:0xf bank_mask:0xc
    s_nop 0
    v_add_f32_dpp v57, v54, v54 row_half_mirror row_mask:0xf bank_mask:0x5
    s_nop 1
    v_add_f32_dpp v57, v55, v55 row_half_mirror row_mask:0xf bank_mask:0xa
    buffer_load_dwordx4 a[124:127], v4, s[44:47], s81 offen offset:128
    s_waitcnt vmcnt(8)
    s_cmp_ge_u32 s27, 72
    s_cbranch_scc1 L_f47
    s_waitcnt vmcnt(6)
L_f47:
    buffer_load_dwordx4 v[156:159], v1, s[32:35], s80 offen offset:3072 nt
    v_sub_u32 v48, v48, v45
    v_cmp_gt_u32 vcc, 64, v48
    s_nop 0
    s_bcnt1_i32_b64 s27, vcc
    s_add_u32 s27, s27, s23
    s_max_i32 s27, s27, 0
    s_mov_b32 s80, 393216
    s_waitcnt vmcnt(8)
    s_cmp_ge_u32 s27, 36
    s_cbranch_scc1 L_f48
    s_waitcnt vmcnt(5)
L_f48:
    buffer_load_dwordx4 v[160:163], v1, s[32:35], s80 offen offset:0 nt
    s_waitcnt vmcnt(8)
    s_cmp_ge_u32 s27, 39
    s_cbranch_scc1 L_f49
    s_waitcnt vmcnt(5)
L_f49:
    buffer_load_dwordx4 v[164:167], v1, s[32:35], s80 offen offset:1024 nt
    s_waitcnt vmcnt(7)
    s_cmp_ge_u32 s27, 43
    s_cbranch_scc1 L_f50
    s_waitcnt vmcnt(5)
L_f50:
    buffer_load_dwordx4 v[184:187], v1, s[32:35], s80 offen offset:2048 nt
    v_dot2_f32_bf16 v50, v128, v64, 0
    v_dot2_f32_bf16 v51, v132, v64, 0
    v_dot2_f32_bf16 v52, v136, v64, 0
    v_dot2_f32_bf16 v53, v140, v64, 0
    v_dot2_f32_bf16 v50, v129, v65, v50
    v_dot2_f32_bf16 v51, v133, v65, v51
    v_dot2_f32_bf16 v52, v137, v65, v52
    v_dot2_f32_bf16 v53, v141, v65, v53
    v_dot2_f32_bf16 v50, v130, v66, v50
    v_dot2_f32_bf16 v51, v134, v66, v51
    v_dot2_f32_bf16 v52, v138, v66, v52
    v_dot2_f32_bf16 v53, v142, v66, v53
    v_dot2_f32_bf16 v50, v131, v67, v50
    v_dot2_f32_bf16 v51, v135, v67, v51
    v_dot2_f32_bf16 v52, v139, v67, v52
    v_dot2_f32_bf16 v53, v143, v67, v53
    v_add_f32_dpp v54, v50, v50 row_ror:8 row_mask:0xf bank_mask:0x3
    v_add_f32_dpp v55, v51, v51 row_ror:8 row_mask:0xf bank_mask:0x3
    s_nop 0
    v_add_f32_dpp v54, v52, v52 row_ror:8 row_mask:0xf bank_mask:0xc
    v_add_f32_dpp v55, v53, v53 row_ror:8 row_mask:0xf bank_mask:0xc
    s_nop 0
    v_add_f32_dpp v58, v54, v54 row_half_mirror row_mask:0xf bank_mask:0x5
    s_nop 1
    v_add_f32_dpp v58, v55, v55 row_half_mirror row_mask:0xf bank_mask:0xa
    s_waitcnt vmcnt(7)
    s_cmp_ge_u32 s27, 46
    s_cbranch_scc1 L_f51
    s_waitcnt vmcnt(5)
L_f51:
    buffer_load_dwordx4 v[188:191], v1, s[32:35], s80 offen offset:3072 nt
    v_add_u32 v45, 1, v45
    buffer_store_dword v45, v46, s[68:71], 0 offen
    buffer_load_dword v48, v47, s[68:71], 0 offen nt
    buffer_load_dwordx4 a[244:247], v5, s[44:47], s81 offen offset:0
    s_mov_b32 s80, 409600
    s_waitcnt vmcnt(10)
    s_cmp_ge_u32 s27, 49
    s_cbranch_scc1 L_f52
    s_waitcnt vmcnt(7)
L_f52:
    buffer_load_dwordx4 v[192:195], v1, s[32:35], s80 offen offset:0 nt
    s_waitcnt vmcnt(10)
    s_cmp_ge_u32 s27, 52
    s_cbranch_scc1 L_f53
    s_waitcnt vmcnt(7)
L_f53:
    buffer_load_dwordx4 v[196:199], v1, s[32:35], s80 offen offset:1024 nt
    s_waitcnt vmcnt(9)
    s_cmp_ge_u32 s27, 56
    s_cbranch_scc1 L_f54
    s_waitcnt vmcnt(7)
L_f54:
    buffer_load_dwordx4 v[200:203], v1, s[32:35], s80 offen offset:2048 nt
    v_dot2_f32_bf16 v50, v144, v64, 0
    v_dot2_f32_bf16 v51, v148, v64, 0
    v_dot2_f32_bf16 v52, v152, v64, 0
    v_dot2_f32_bf16 v53, v156, v64, 0
    v_dot2_f32_bf16 v50, v145, v65, v50
    v_dot2_f32_bf16 v51, v149, v65, v51
    v_dot2_f32_bf16 v52, v153, v65, v52
    v_dot2_f32_bf16 v53, v157, v65, v53
    v_dot2_f32_bf16 v50, v146, v66, v50
    v_dot2_f32_bf16 v51, v150, v66, v51
    v_dot2_f32_bf16 v52, v154, v66, v52
    v_dot2_f32_bf16 v53, v158, v66, v53
    v_dot2_f32_bf16 v50, v147, v67, v50
    v_dot2_f32_bf16 v51, v151, v67, v51
    v_dot2_f32_bf16 v52, v155, v67, v52
    v_dot2_f32_bf16 v53, v159, v67, v53
    v_add_f32_dpp v54, v50, v50 row_ror:8 row_mask:0xf bank_mask:0x3
    v_add_f32_dpp v55, v51, v51 row_ror:8 row_mask:0xf bank_mask:0x3
    s_nop 0
    v_add_f32_dpp v54, v52, v52 row_ror:8 row_mask:0xf bank_mask:0xc
    v_add_f32_dpp v55, v53, v53 row_ror:8 row_mask:0xf bank_mask:0xc
    s_nop 0
    v_add_f32_dpp v59, v54, v54 row_half_mirror row_mask:0xf bank_mask:0x5
    s_nop 1
    v_add_f32_dpp v59, v55, v55 row_half_mirror row_mask:0xf bank_mask:0xa
    v_cndmask_b32 v50, v56, v58, s[82:83]
    v_cndmask_b32 v51, v58, v56, s[82:83]
    v_cndmask_b32 v52, v57, v59, s[82:83]
    v_cndmask_b32 v53, v59, v57, s[82:83]
    v_add_f32_dpp v54, v51, v50 quad_perm:[2,3,0,1] row_mask:0xf bank_mask:0xf
    s_nop 0
    v_add_f32_dpp v55, v53, v52 quad_perm:[2,3,0,1] row_mask:0xf bank_mask:0xf
    v_cndmask_b32 v60, v54, v55, s[84:85]
    v_cndmask_b32 v61, v55, v54, s[84:85]
    s_nop 1
    v_add_f32_dpp v30, v61, v60 quad_perm:[1,0,3,2] row_mask:0xf bank_mask:0xf
    s_waitcnt vmcnt(9)
    s_cmp_ge_u32 s27, 59
    s_cbranch_scc1 L_f55
    s_waitcnt vmcnt(7)
L_f55:
    buffer_load_dwordx4 v[204:207], v1, s[32:35], s80 offen offset:3072 nt
    s_lshl1_add_u32 s81, s3, 1
    s_and_b32 s81, s81, 7
    s_mulk_i32 s81, 4608
    buffer_load_dwordx4 a[128:131], v4, s[44:47], s81 offen offset:0
    s_mov_b32 s80, 425984
    s_waitcnt vmcnt(10)
    s_cmp_ge_u32 s27, 62
    s_cbranch_scc1 L_f56
    s_waitcnt vmcnt(8)
L_f56:
    buffer_load_dwordx4 v[208:211], v1, s[32:35], s80 offen offset:0 nt
    s_waitcnt vmcnt(10)
    s_cmp_ge_u32 s27, 66
    s_cbranch_scc1 L_f57
    s_waitcnt vmcnt(5)
L_f57:
    buffer_load_dwordx4 v[212:215], v1, s[32:35], s80 offen offset:1024 nt
    s_waitcnt vmcnt(10)
    s_cmp_ge_u32 s27, 69
    s_cbranch_scc1 L_f58
    s_waitcnt vmcnt(5)
L_f58:
    buffer_load_dwordx4 v[216:219], v1, s[32:35], s80 offen offset:2048 nt
    v_dot2_f32_bf16 v50, v160, v64, 0
    v_dot2_f32_bf16 v51, v164, v64, 0
    v_dot2_f32_bf16 v52, v184, v64, 0
    v_dot2_f32_bf16 v53, v188, v64, 0
    v_dot2_f32_bf16 v50, v161, v65, v50
    v_dot2_f32_bf16 v51, v165, v65, v51
    v_dot2_f32_bf16 v52, v185, v65, v52
    v_dot2_f32_bf16 v53, v189, v65, v53
    v_dot2_f32_bf16 v50, v162, v66, v50
    v_dot2_f32_bf16 v51, v166, v66, v51
    v_dot2_f32_bf16 v52, v186, v66, v52
    v_dot2_f32_bf16 v53, v190, v66, v53
    v_dot2_f32_bf16 v50, v163, v67, v50
    v_dot2_f32_bf16 v51, v167, v67, v51
    v_dot2_f32_bf16 v52, v187, v67, v52
    v_dot2_f32_bf16 v53, v191, v67, v53
    v_add_f32_dpp v54, v50, v50 row_ror:8 row_mask:0xf bank_mask:0x3
    v_add_f32_dpp v55, v51, v51 row_ror:8 row_mask:0xf bank_mask:0x3
    s_nop 0
    v_add_f32_dpp v54, v52, v52 row_ror:8 row_mask:0xf bank_mask:0xc
    v_add_f32_dpp v55, v53, v53 row_ror:8 row_mask:0xf bank_mask:0xc
    s_nop 0
    v_add_f32_dpp v56, v54, v54 row_half_mirror row_mask:0xf bank_mask:0x5
    s_nop 1
    v_add_f32_dpp v56, v55, v55 row_half_mirror row_mask:0xf bank_mask:0xa
    s_waitcnt vmcnt(7)
    s_cmp_ge_u32 s27, 72
    s_cbranch_scc1 L_f59
    s_waitcnt vmcnt(5)
L_f59:
    buffer_load_dwordx4 v[220:223], v1, s[32:35], s80 offen offset:3072 nt
    v_lshrrev_b32 v25, 3, v0
    v_lshl_add_u32 v3, v25, 4, v62
    buffer_load_dwordx4 v[224:227], v3, s[68:71], 0 offen
    buffer_load_dwordx4 v[228:231], v62, s[68:71], 0 offen offset:128
    v_sub_u32 v48, v48, v45
    v_cmp_gt_u32 vcc, 64, v48
    s_nop 0
    s_bcnt1_i32_b64 s27, vcc
    s_add_u32 s27, s27, s23
    s_max_i32 s27, s27, 0
    s_mov_b32 s80, 442368
    s_waitcnt vmcnt(9)
    s_cmp_ge_u32 s27, 36
    s_cbranch_scc1 L_f60
    s_waitcnt vmcnt(7)
L_f60:
    buffer_load_dwordx4 v[232:235], v1, s[32:35], s80 offen offset:0 nt
    buffer_load_dwordx4 a[136:139], v4, s[44:47], s81 offen offset:128
    s_waitcnt vmcnt(10)
    s_cmp_ge_u32 s27, 39
    s_cbranch_scc1 L_f61
    s_waitcnt vmcnt(7)
L_f61:
    buffer_load_dwordx4 v[236:239], v1, s[32:35], s80 offen offset:1024 nt
    s_waitcnt vmcnt(10)
    s_cmp_ge_u32 s27, 43
    s_cbranch_scc1 L_f62
    s_waitcnt vmcnt(7)
L_f62:
    buffer_load_dwordx4 v[240:243], v1, s[32:35], s80 offen offset:2048 nt
    v_dot2_f32_bf16 v50, v192, v64, 0
    v_dot2_f32_bf16 v51, v196, v64, 0
    v_dot2_f32_bf16 v52, v200, v64, 0
    v_dot2_f32_bf16 v53, v204, v64, 0
    v_dot2_f32_bf16 v50, v193, v65, v50
    v_dot2_f32_bf16 v51, v197, v65, v51
    v_dot2_f32_bf16 v52, v201, v65, v52
    v_dot2_f32_bf16 v53, v205, v65, v53
    v_dot2_f32_bf16 v50, v194, v66, v50
    v_dot2_f32_bf16 v51, v198, v66, v51
    v_dot2_f32_bf16 v52, v202, v66, v52
    v_dot2_f32_bf16 v53, v206, v66, v53
    v_dot2_f32_bf16 v50, v195, v67, v50
    v_dot2_f32_bf16 v51, v199, v67, v51
    v_dot2_f32_bf16 v52, v203, v67, v52
    v_dot2_f32_bf16 v53, v207, v67, v53
    v_add_f32_dpp v54, v50, v50 row_ror:8 row_mask:0xf bank_mask:0x3
    v_add_f32_dpp v55, v51, v51 row_ror:8 row_mask:0xf bank_mask:0x3
    s_nop 0
    v_add_f32_dpp v54, v52, v52 row_ror:8 row_mask:0xf bank_mask:0xc
    v_add_f32_dpp v55, v53, v53 row_ror:8 row_mask:0xf bank_mask:0xc
    s_nop 0
    v_add_f32_dpp v57, v54, v54 row_half_mirror row_mask:0xf bank_mask:0x5
    s_nop 1
    v_add_f32_dpp v57, v55, v55 row_half_mirror row_mask:0xf bank_mask:0xa
    s_waitcnt vmcnt(9)
    s_cmp_ge_u32 s27, 46
    s_cbranch_scc1 L_f63
    s_waitcnt vmcnt(7)
L_f63:
    buffer_load_dwordx4 v[244:247], v1, s[32:35], s80 offen offset:3072 nt
    v_add_u32 v45, 1, v45
    buffer_store_dword v45, v46, s[68:71], 0 offen
    buffer_load_dword v48, v47, s[68:71], 0 offen nt
    s_mov_b32 s80, 524288
    s_waitcnt vmcnt(11)
    s_cmp_ge_u32 s27, 49
    s_cbranch_scc1 L_f64
    s_waitcnt vmcnt(9)
L_f64:
    buffer_load_dwordx4 v[248:251], v1, s[32:35], s80 offen offset:0 nt
    buffer_load_dwordx4 a[248:251], v5, s[44:47], s81 offen offset:0
    s_waitcnt vmcnt(12)
    s_cmp_ge_u32 s27, 52
    s_cbranch_scc1 L_f65
    s_waitcnt vmcnt(8)
L_f65:
    buffer_load_dwordx4 v[252:255], v1, s[32:35], s80 offen offset:1024 nt
    s_waitcnt vmcnt(12)
    s_cmp_ge_u32 s27, 56
    s_cbranch_scc1 L_f66
    s_waitcnt vmcnt(7)
L_f66:
    buffer_load_dwordx4 v[168:171], v1, s[32:35], s80 offen offset:2048 nt
    v_dot2_f32_bf16 v50, v208, v64, 0
    v_dot2_f32_bf16 v51, v212, v64, 0
    v_dot2_f32_bf16 v52, v216, v64, 0
    v_dot2_f32_bf16 v53, v220, v64, 0
    v_dot2_f32_bf16 v50, v209, v65, v50
    v_dot2_f32_bf16 v51, v213, v65, v51
    v_dot2_f32_bf16 v52, v217, v65, v52
    v_dot2_f32_bf16 v53, v221, v65, v53
    v_dot2_f32_bf16 v50, v210, v66, v50
    v_dot2_f32_bf16 v51, v214, v66, v51
    v_dot2_f32_bf16 v52, v218, v66, v52
    v_dot2_f32_bf16 v53, v222, v66, v53
    v_dot2_f32_bf16 v50, v211, v67, v50
    v_dot2_f32_bf16 v51, v215, v67, v51
    v_dot2_f32_bf16 v52, v219, v67, v52
    v_dot2_f32_bf16 v53, v223, v67, v53
    v_add_f32_dpp v54, v50, v50 row_ror:8 row_mask:0xf bank_mask:0x3
    v_add_f32_dpp v55, v51, v51 row_ror:8 row_mask:0xf bank_mask:0x3
    s_nop 0
    v_add_f32_dpp v54, v52, v52 row_ror:8 row_mask:0xf bank_mask:0xc
    v_add_f32_dpp v55, v53, v53 row_ror:8 row_mask:0xf bank_mask:0xc
    s_nop 0
    v_add_f32_dpp v58, v54, v54 row_half_mirror row_mask:0xf bank_mask:0x5
    s_nop 1
    v_add_f32_dpp v58, v55, v55 row_half_mirror row_mask:0xf bank_mask:0xa
    s_waitcnt vmcnt(10)
    s_cmp_ge_u32 s27, 59
    s_cbranch_scc1 L_f67
    s_waitcnt vmcnt(7)
L_f67:
    buffer_load_dwordx4 v[172:175], v1, s[32:35], s80 offen offset:3072 nt
    s_mov_b32 s92, 0x40000
L_h:
    v_xor_b32 v96, s76, v224
    v_xor_b32 v100, s76, v228
    v_xor_b32 v97, s77, v225
    v_xor_b32 v101, s77, v229
    v_xor_b32 v98, s78, v226
    v_xor_b32 v102, s78, v230
    v_xor_b32 v99, s79, v227
    v_xor_b32 v103, s79, v231
    v_or3_b32 v24, v96, v97, v98
    v_or3_b32 v24, v24, v99, v100
    v_or3_b32 v24, v24, v101, v102
    v_or_b32 v24, v24, v103
    v_and_b32 v24, 0xff, v24
    v_cmp_gt_u32 s[4:5], v15, v62
    v_cmp_ne_u32 vcc, 0, v24
    s_nop 1
    s_and_b64 vcc, vcc, s[4:5]
    s_cbranch_vccz L_h_ok
    s_sub_u32 s92, s92, 1
    s_cbranch_scc1 L_h_ok
    s_sleep 1
    buffer_load_dwordx4 v[224:227], v3, s[68:71], 0 offen sc1
    buffer_load_dwordx4 v[228:231], v62, s[68:71], 0 offen offset:128 sc1
    s_waitcnt vmcnt(0)
    s_branch L_h
L_h_ok:
    v_and_b32 v24, 8, v0
    v_cmp_ne_u32 vcc, 0, v24
    s_nop 1
    v_cndmask_b32 v100, v100, v101, vcc
    v_cndmask_b32 v102, v102, v103, vcc
    v_and_b32 v24, 16, v0
    v_cmp_ne_u32 vcc, 0, v24
    s_nop 1
    v_cndmask_b32 v100, v100, v102, vcc
    v_cndmask_b32 v96, 0, v96, s[4:5]
    v_cndmask_b32 v97, 0, v97, s[4:5]
    v_cndmask_b32 v98, 0, v98, s[4:5]
    v_cndmask_b32 v99, 0, v99, s[4:5]
    v_cndmask_b32 v100, 0, v100, s[4:5]
    v_add_f32_dpp v96, v96, v96 quad_perm:[1,0,3,2] row_mask:0xf bank_mask:0xf
    v_add_f32_dpp v97, v97, v97 quad_perm:[1,0,3,2] row_mask:0xf bank_mask:0xf
    v_add_f32_dpp v98, v98, v98 quad_perm:[1,0,3,2] row_mask:0xf bank_mask:0xf
    v_add_f32_dpp v99, v99, v99 quad_perm:[1,0,3,2] row_mask:0xf bank_mask:0xf
    v_add_f32_dpp v100, v100, v100 quad_perm:[1,0,3,2] row_mask:0xf bank_mask:0xf
    v_add_f32_dpp v96, v96, v96 quad_perm:[2,3,0,1] row_mask:0xf bank_mask:0xf
    v_add_f32_dpp v97, v97, v97 quad_perm:[2,3,0,1] row_mask:0xf bank_mask:0xf
    v_add_f32_dpp v98, v98, v98 quad_perm:[2,3,0,1] row_mask:0xf bank_mask:0xf
    v_add_f32_dpp v99, v99, v99 quad_perm:[2,3,0,1] row_mask:0xf bank_mask:0xf
    v_add_f32_dpp v100, v100, v100 quad_perm:[2,3,0,1] row_mask:0xf bank_mask:0xf
    v_add_f32_dpp v96, v96, v96 row_half_mirror row_mask:0xf bank_mask:0xf
    v_add_f32_dpp v97, v97, v97 row_half_mirror row_mask:0xf bank_mask:0xf
    v_add_f32_dpp v98, v98, v98 row_half_mirror row_mask:0xf bank_mask:0xf
    v_add_f32_dpp v99, v99, v99 row_half_mirror row_mask:0xf bank_mask:0xf
    v_add_f32_dpp v100, v100, v100 row_half_mirror row_mask:0xf bank_mask:0xf
    s_mov_b32 s80, 540672
    s_waitcnt vmcnt(9)
    s_cmp_ge_u32 s27, 62
    s_cbranch_scc1 L_f68
    s_waitcnt vmcnt(7)
L_f68:
    buffer_load_dwordx4 v[176:179], v1, s[32:35], s80 offen offset:0 nt
    v_sub_f32 v106, 1.0, v12
    s_mov_b32 s90, 0xbfb8aa3b
    v_lshlrev_b32 v101, 16, v42
    v_add_f32 v96, v96, v101
    v_mul_f32 v101, s90, abs(v96)
    v_exp_f32 v101, v101
    v_cmp_le_f32 vcc, 0, v96
    v_mul_f32 v102, v101, v101
    s_nop 0
    v_cndmask_b32 v103, v102, 1.0, vcc
    v_cndmask_b32 v105, 1.0, v102, vcc
    v_fma_f32 v103, 2.0, v101, v103
    v_fma_f32 v104, 2.0, v105, v103
    v_rcp_f32 v104, v104
    v_mul_f32 v103, v103, v96
    v_mul_f32 v103, v103, v104
    v_mul_f32 v103, v103, v106
    v_cvt_pk_bf16_f32 v36, v103, v103
    v_and_b32 v101, 0xffff0000, v42
    v_add_f32 v97, v97, v101
    v_mul_f32 v101, s90, abs(v97)
    v_exp_f32 v101, v101
    v_cmp_le_f32 vcc, 0, v97
    v_mul_f32 v102, v101, v101
    s_nop 0
    v_cndmask_b32 v103, v102, 1.0, vcc
    v_cndmask_b32 v105, 1.0, v102, vcc
    v_fma_f32 v103, 2.0, v101, v103
    v_fma_f32 v104, 2.0, v105, v103
    v_rcp_f32 v104, v104
    v_mul_f32 v103, v103, v97
    v_mul_f32 v103, v103, v104
    v_mul_f32 v103, v103, v106
    v_cvt_pk_bf16_f32 v37, v103, v103
    v_lshlrev_b32 v101, 16, v43
    v_add_f32 v98, v98, v101
    v_mul_f32 v101, s90, abs(v98)
    v_exp_f32 v101, v101
    v_cmp_le_f32 vcc, 0, v98
    v_mul_f32 v102, v101, v101
    s_nop 0
    v_cndmask_b32 v103, v102, 1.0, vcc
    v_cndmask_b32 v105, 1.0, v102, vcc
    v_fma_f32 v103, 2.0, v101, v103
    v_fma_f32 v104, 2.0, v105, v103
    v_rcp_f32 v104, v104
    v_mul_f32 v103, v103, v98
    v_mul_f32 v103, v103, v104
    v_mul_f32 v103, v103, v106
    v_cvt_pk_bf16_f32 v38, v103, v103
    v_and_b32 v101, 0xffff0000, v43
    v_add_f32 v99, v99, v101
    v_mul_f32 v101, s90, abs(v99)
    v_exp_f32 v101, v101
    v_cmp_le_f32 vcc, 0, v99
    v_mul_f32 v102, v101, v101
    s_nop 0
    v_cndmask_b32 v103, v102, 1.0, vcc
    v_cndmask_b32 v105, 1.0, v102, vcc
    v_fma_f32 v103, 2.0, v101, v103
    v_fma_f32 v104, 2.0, v105, v103
    v_rcp_f32 v104, v104
    v_mul_f32 v103, v103, v99
    v_mul_f32 v103, v103, v104
    v_mul_f32 v103, v103, v106
    v_cvt_pk_bf16_f32 v39, v103, v103
    v_lshlrev_b32 v101, 16, v44
    v_add_f32 v100, v100, v101
    v_mul_f32 v101, s90, abs(v100)
    v_exp_f32 v101, v101
    v_cmp_le_f32 vcc, 0, v100
    v_mul_f32 v102, v101, v101
    s_nop 0
    v_cndmask_b32 v103, v102, 1.0, vcc
    v_cndmask_b32 v105, 1.0, v102, vcc
    v_fma_f32 v103, 2.0, v101, v103
    v_fma_f32 v104, 2.0, v105, v103
    v_rcp_f32 v104, v104
    v_mul_f32 v103, v103, v100
    v_mul_f32 v103, v103, v104
    v_mul_f32 v103, v103, v106
    v_cvt_pk_bf16_f32 v40, v103, v103
    v_mov_b32 v41, v36
    s_cmp_eq_u32 s3, 1
    s_cselect_b64 vcc, -1, 0
    v_cndmask_b32 v41, v41, v37, vcc
    s_cmp_eq_u32 s3, 2
    s_cselect_b64 vcc, -1, 0
    v_cndmask_b32 v41, v41, v38, vcc
    s_cmp_eq_u32 s3, 3
    s_cselect_b64 vcc, -1, 0
    v_cndmask_b32 v41, v41, v39, vcc
    s_waitcnt vmcnt(9)
    s_cmp_ge_u32 s27, 66
    s_cbranch_scc1 L_f69
    s_waitcnt vmcnt(5)
L_f69:
    buffer_load_dwordx4 v[180:183], v1, s[32:35], s80 offen offset:1024 nt
    s_add_u32 s81, s81, 73728
    buffer_load_dwordx4 a[132:135], v4, s[44:47], s81 offen offset:0
    s_waitcnt vmcnt(10)
    s_cmp_ge_u32 s27, 69
    s_cbranch_scc1 L_f70
    s_waitcnt vmcnt(5)
L_f70:
    buffer_load_dwordx4 v[112:115], v1, s[32:35], s80 offen offset:2048 nt
    v_dot2_f32_bf16 v50, v232, v64, 0
    v_dot2_f32_bf16 v51, v236, v64, 0
    v_dot2_f32_bf16 v52, v240, v64, 0
    v_dot2_f32_bf16 v53, v244, v64, 0
    v_dot2_f32_bf16 v50, v233, v65, v50
    v_dot2_f32_bf16 v51, v237, v65, v51
    v_dot2_f32_bf16 v52, v241, v65, v52
    v_dot2_f32_bf16 v53, v245, v65, v53
    v_dot2_f32_bf16 v50, v234, v66, v50
    v_dot2_f32_bf16 v51, v238, v66, v51
    v_dot2_f32_bf16 v52, v242, v66, v52
    v_dot2_f32_bf16 v53, v246, v66, v53
    v_dot2_f32_bf16 v50, v235, v67, v50
    v_dot2_f32_bf16 v51, v239, v67, v51
    v_dot2_f32_bf16 v52, v243, v67, v52
    v_dot2_f32_bf16 v53, v247, v67, v53
    v_add_f32_dpp v54, v50, v50 row_ror:8 row_mask:0xf bank_mask:0x3
    v_add_f32_dpp v55, v51, v51 row_ror:8 row_mask:0xf bank_mask:0x3
    s_nop 0
    v_add_f32_dpp v54, v52, v52 row_ror:8 row_mask:0xf bank_mask:0xc
    v_add_f32_dpp v55, v53, v53 row_ror:8 row_mask:0xf bank_mask:0xc
    s_nop 0
    v_add_f32_dpp v59, v54, v54 row_half_mirror row_mask:0xf bank_mask:0x5
    s_nop 1
    v_add_f32_dpp v59, v55, v55 row_half_mirror row_mask:0xf bank_mask:0xa
    v_cndmask_b32 v50, v56, v58, s[82:83]
    v_cndmask_b32 v51, v58, v56, s[82:83]
    v_cndmask_b32 v52, v57, v59, s[82:83]
    v_cndmask_b32 v53, v59, v57, s[82:83]
    v_add_f32_dpp v54, v51, v50 quad_perm:[2,3,0,1] row_mask:0xf bank_mask:0xf
    s_nop 0
    v_add_f32_dpp v55, v53, v52 quad_perm:[2,3,0,1] row_mask:0xf bank_mask:0xf
    v_cndmask_b32 v60, v54, v55, s[84:85]
    v_cndmask_b32 v61, v55, v54, s[84:85]
    s_nop 1
    v_add_f32_dpp v31, v61, v60 quad_perm:[1,0,3,2] row_mask:0xf bank_mask:0xf
    s_waitcnt vmcnt(8)
    s_cmp_ge_u32 s27, 72
    s_cbranch_scc1 L_f71
    s_waitcnt vmcnt(5)
L_f71:
    buffer_load_dwordx4 v[116:119], v1, s[32:35], s80 offen offset:3072 nt
    v_sub_u32 v48, v48, v45
    v_cmp_gt_u32 vcc, 64, v48
    s_nop 0
    s_bcnt1_i32_b64 s27, vcc
    s_add_u32 s27, s27, s23
    s_max_i32 s27, s27, 0
    s_mov_b32 s80, 557056
    s_waitcnt vmcnt(7)
    s_cmp_ge_u32 s27, 36
    s_cbranch_scc1 L_f72
    s_waitcnt vmcnt(5)
L_f72:
    buffer_load_dwordx4 v[120:123], v1, s[32:35], s80 offen offset:0 nt
    s_waitcnt vmcnt(7)
    s_cmp_ge_u32 s27, 39
    s_cbranch_scc1 L_f73
    s_waitcnt vmcnt(5)
L_f73:
    buffer_load_dwordx4 v[124:127], v1, s[32:35], s80 offen offset:1024 nt
    buffer_load_dwordx4 a[140:143], v4, s[44:47], s81 offen offset:128
    s_waitcnt vmcnt(8)
    s_cmp_ge_u32 s27, 43
    s_cbranch_scc1 L_f74
    s_waitcnt vmcnt(6)
L_f74:
    buffer_load_dwordx4 v[128:131], v1, s[32:35], s80 offen offset:2048 nt
    v_dot2_f32_bf16 v50, v248, v64, 0
    v_dot2_f32_bf16 v51, v252, v64, 0
    v_dot2_f32_bf16 v52, v168, v64, 0
    v_dot2_f32_bf16 v53, v172, v64, 0
    v_dot2_f32_bf16 v50, v249, v65, v50
    v_dot2_f32_bf16 v51, v253, v65, v51
    v_dot2_f32_bf16 v52, v169, v65, v52
    v_dot2_f32_bf16 v53, v173, v65, v53
    v_dot2_f32_bf16 v50, v250, v66, v50
    v_dot2_f32_bf16 v51, v254, v66, v51
    v_dot2_f32_bf16 v52, v170, v66, v52
    v_dot2_f32_bf16 v53, v174, v66, v53
    v_dot2_f32_bf16 v50, v251, v67, v50
    v_dot2_f32_bf16 v51, v255, v67, v51
    v_dot2_f32_bf16 v52, v171, v67, v52
    v_dot2_f32_bf16 v53, v175, v67, v53
    v_add_f32_dpp v54, v50, v50 row_ror:8 row_mask:0xf bank_mask:0x3
    v_add_f32_dpp v55, v51, v51 row_ror:8 row_mask:0xf bank_mask:0x3
    s_nop 0
    v_add_f32_dpp v54, v52, v52 row_ror:8 row_mask:0xf bank_mask:0xc
    v_add_f32_dpp v55, v53, v53 row_ror:8 row_mask:0xf bank_mask:0xc
    s_nop 0
    v_add_f32_dpp v56, v54, v54 row_half_mirror row_mask:0xf bank_mask:0x5
    s_nop 1
    v_add_f32_dpp v56, v55, v55 row_half_mirror row_mask:0xf bank_mask:0xa
    s_waitcnt vmcnt(8)
    s_cmp_ge_u32 s27, 46
    s_cbranch_scc1 L_f75
    s_waitcnt vmcnt(5)
L_f75:
    buffer_load_dwordx4 v[132:135], v1, s[32:35], s80 offen offset:3072 nt
    v_add_u32 v45, 1, v45
    buffer_store_dword v45, v46, s[68:71], 0 offen
    buffer_load_dword v48, v47, s[68:71], 0 offen nt
    s_mov_b32 s80, 573440
    s_waitcnt vmcnt(10)
    s_cmp_ge_u32 s27, 49
    s_cbranch_scc1 L_f76
    s_waitcnt vmcnt(7)
L_f76:
    buffer_load_dwordx4 v[136:139], v1, s[32:35], s80 offen offset:0 nt
    s_waitcnt vmcnt(9)
    s_cmp_ge_u32 s27, 52
    s_cbranch_scc1 L_f77
    s_waitcnt vmcnt(7)
L_f77:
    buffer_load_dwordx4 v[140:143], v1, s[32:35], s80 offen offset:1024 nt
    s_waitcnt vmcnt(9)
    s_cmp_ge_u32 s27, 56
    s_cbranch_scc1 L_f78
    s_waitcnt vmcnt(7)
L_f78:
    buffer_load_dwordx4 v[144:147], v1, s[32:35], s80 offen offset:2048 nt
    v_dot2_f32_bf16 v50, v176, v64, 0
    v_dot2_f32_bf16 v51, v180, v64, 0
    v_dot2_f32_bf16 v52, v112, v64, 0
    v_dot2_f32_bf16 v53, v116, v64, 0
    v_dot2_f32_bf16 v50, v177, v65, v50
    v_dot2_f32_bf16 v51, v181, v65, v51
    v_dot2_f32_bf16 v52, v113, v65, v52
    v_dot2_f32_bf16 v53, v117, v65, v53
    v_dot2_f32_bf16 v50, v178, v66, v50
    v_dot2_f32_bf16 v51, v182, v66, v51
    v_dot2_f32_bf16 v52, v114, v66, v52
    v_dot2_f32_bf16 v53, v118, v66, v53
    v_dot2_f32_bf16 v50, v179, v67, v50
    v_dot2_f32_bf16 v51, v183, v67, v51
    v_dot2_f32_bf16 v52, v115, v67, v52
    v_dot2_f32_bf16 v53, v119, v67, v53
    v_add_f32_dpp v54, v50, v50 row_ror:8 row_mask:0xf bank_mask:0x3
    v_add_f32_dpp v55, v51, v51 row_ror:8 row_mask:0xf bank_mask:0x3
    s_nop 0
    v_add_f32_dpp v54, v52, v52 row_ror:8 row_mask:0xf bank_mask:0xc
    v_add_f32_dpp v55, v53, v53 row_ror:8 row_mask:0xf bank_mask:0xc
    s_nop 0
    v_add_f32_dpp v57, v54, v54 row_half_mirror row_mask:0xf bank_mask:0x5
    s_nop 1
    v_add_f32_dpp v57, v55, v55 row_half_mirror row_mask:0xf bank_mask:0xa
    buffer_load_dwordx4 a[252:255], v5, s[44:47], s81 offen offset:0
    s_waitcnt vmcnt(10)
    s_cmp_ge_u32 s27, 59
    s_cbranch_scc1 L_f79
    s_waitcnt vmcnt(7)
L_f79:
    buffer_load_dwordx4 v[148:151], v1, s[32:35], s80 offen offset:3072 nt
    s_mov_b32 s80, 655360
    s_waitcnt vmcnt(10)
    s_cmp_ge_u32 s27, 62
    s_cbranch_scc1 L_f80
    s_waitcnt vmcnt(7)
L_f80:
    buffer_load_dwordx4 v[152:155], v1, s[32:35], s80 offen offset:0 nt
    s_waitcnt vmcnt(9)
    s_cmp_ge_u32 s27, 66
    s_cbranch_scc1 L_f81
    s_waitcnt vmcnt(5)
L_f81:
    buffer_load_dwordx4 v[156:159], v1, s[32:35], s80 offen offset:1024 nt
    s_waitcnt vmcnt(9)
    s_cmp_ge_u32 s27, 69
    s_cbranch_scc1 L_f82
    s_waitcnt vmcnt(5)
L_f82:
    buffer_load_dwordx4 v[160:163], v1, s[32:35], s80 offen offset:2048 nt
    v_dot2_f32_bf16 v50, v120, v64, 0
    v_dot2_f32_bf16 v51, v124, v64, 0
    v_dot2_f32_bf16 v52, v128, v64, 0
    v_dot2_f32_bf16 v53, v132, v64, 0
    v_dot2_f32_bf16 v50, v121, v65, v50
    v_dot2_f32_bf16 v51, v125, v65, v51
    v_dot2_f32_bf16 v52, v129, v65, v52
    v_dot2_f32_bf16 v53, v133, v65, v53
    v_dot2_f32_bf16 v50, v122, v66, v50
    v_dot2_f32_bf16 v51, v126, v66, v51
    v_dot2_f32_bf16 v52, v130, v66, v52
    v_dot2_f32_bf16 v53, v134, v66, v53
    v_dot2_f32_bf16 v50, v123, v67, v50
    v_dot2_f32_bf16 v51, v127, v67, v51
    v_dot2_f32_bf16 v52, v131, v67, v52
    v_dot2_f32_bf16 v53, v135, v67, v53
    v_add_f32_dpp v54, v50, v50 row_ror:8 row_mask:0xf bank_mask:0x3
    v_add_f32_dpp v55, v51, v51 row_ror:8 row_mask:0xf bank_mask:0x3
    s_nop 0
    v_add_f32_dpp v54, v52, v52 row_ror:8 row_mask:0xf bank_mask:0xc
    v_add_f32_dpp v55, v53, v53 row_ror:8 row_mask:0xf bank_mask:0xc
    s_nop 0
    v_add_f32_dpp v58, v54, v54 row_half_mirror row_mask:0xf bank_mask:0x5
    s_nop 1
    v_add_f32_dpp v58, v55, v55 row_half_mirror row_mask:0xf bank_mask:0xa
    s_lshl1_add_u32 s81, s3, 2
    s_and_b32 s81, s81, 7
    s_mulk_i32 s81, 4608
    buffer_load_dwordx4 a[144:147], v4, s[44:47], s81 offen offset:0
    s_waitcnt vmcnt(8)
    s_cmp_ge_u32 s27, 72
    s_cbranch_scc1 L_f83
    s_waitcnt vmcnt(6)
L_f83:
    buffer_load_dwordx4 v[164:167], v1, s[32:35], s80 offen offset:3072 nt
    v_sub_u32 v48, v48, v45
    v_cmp_gt_u32 vcc, 64, v48
    s_nop 0
    s_bcnt1_i32_b64 s27, vcc
    s_add_u32 s27, s27, s23
    s_max_i32 s27, s27, 0
    s_mov_b32 s80, 671744
    s_waitcnt vmcnt(8)
    s_cmp_ge_u32 s27, 36
    s_cbranch_scc1 L_f84
    s_waitcnt vmcnt(5)
L_f84:
    buffer_load_dwordx4 v[184:187], v1, s[32:35], s80 offen offset:0 nt
    s_waitcnt vmcnt(8)
    s_cmp_ge_u32 s27, 39
    s_cbranch_scc1 L_f85
    s_waitcnt vmcnt(5)
L_f85:
    buffer_load_dwordx4 v[188:191], v1, s[32:35], s80 offen offset:1024 nt
    s_waitcnt vmcnt(7)
    s_cmp_ge_u32 s27, 43
    s_cbranch_scc1 L_f86
    s_waitcnt vmcnt(5)
L_f86:
    buffer_load_dwordx4 v[192:195], v1, s[32:35], s80 offen offset:2048 nt
    v_dot2_f32_bf16 v50, v136, v64, 0
    v_dot2_f32_bf16 v51, v140, v64, 0
    v_dot2_f32_bf16 v52, v144, v64, 0
    v_dot2_f32_bf16 v53, v148, v64, 0
    v_dot2_f32_bf16 v50, v137, v65, v50
    v_dot2_f32_bf16 v51, v141, v65, v51
    v_dot2_f32_bf16 v52, v145, v65, v52
    v_dot2_f32_bf16 v53, v149, v65, v53
    v_dot2_f32_bf16 v50, v138, v66, v50
    v_dot2_f32_bf16 v51, v142, v66, v51
    v_dot2_f32_bf16 v52, v146, v66, v52
    v_dot2_f32_bf16 v53, v150, v66, v53
    v_dot2_f32_bf16 v50, v139, v67, v50
    v_dot2_f32_bf16 v51, v143, v67, v51
    v_dot2_f32_bf16 v52, v147, v67, v52
    v_dot2_f32_bf16 v53, v151, v67, v53
    v_add_f32_dpp v54, v50, v50 row_ror:8 row_mask:0xf bank_mask:0x3
    v_add_f32_dpp v55, v51, v51 row_ror:8 row_mask:0xf bank_mask:0x3
    s_nop 0
    v_add_f32_dpp v54, v52, v52 row_ror:8 row_mask:0xf bank_mask:0xc
    v_add_f32_dpp v55, v53, v53 row_ror:8 row_mask:0xf bank_mask:0xc
    s_nop 0
    v_add_f32_dpp v59, v54, v54 row_half_mirror row_mask:0xf bank_mask:0x5
    s_nop 1
    v_add_f32_dpp v59, v55, v55 row_half_mirror row_mask:0xf bank_mask:0xa
    v_cndmask_b32 v50, v56, v58, s[82:83]
    v_cndmask_b32 v51, v58, v56, s[82:83]
    v_cndmask_b32 v52, v57, v59, s[82:83]
    v_cndmask_b32 v53, v59, v57, s[82:83]
    v_add_f32_dpp v54, v51, v50 quad_perm:[2,3,0,1] row_mask:0xf bank_mask:0xf
    s_nop 0
    v_add_f32_dpp v55, v53, v52 quad_perm:[2,3,0,1] row_mask:0xf bank_mask:0xf
    v_cndmask_b32 v60, v54, v55, s[84:85]
    v_cndmask_b32 v61, v55, v54, s[84:85]
    s_nop 1
    v_add_f32_dpp v32, v61, v60 quad_perm:[1,0,3,2] row_mask:0xf bank_mask:0xf
    s_waitcnt vmcnt(7)
    s_cmp_ge_u32 s27, 46
    s_cbranch_scc1 L_f87
    s_waitcnt vmcnt(5)
L_f87:
    buffer_load_dwordx4 v[196:199], v1, s[32:35], s80 offen offset:3072 nt
    v_add_u32 v45, 1, v45
    buffer_store_dword v45, v46, s[68:71], 0 offen
    buffer_load_dword v48, v47, s[68:71], 0 offen nt
    buffer_load_dwordx4 a[152:155], v4, s[44:47], s81 offen offset:128
    s_mov_b32 s80, 688128
    s_waitcnt vmcnt(10)
    s_cmp_ge_u32 s27, 49
    s_cbranch_scc1 L_f88
    s_waitcnt vmcnt(7)
L_f88:
    buffer_load_dwordx4 v[200:203], v1, s[32:35], s80 offen offset:0 nt
    s_waitcnt vmcnt(10)
    s_cmp_ge_u32 s27, 52
    s_cbranch_scc1 L_f89
    s_waitcnt vmcnt(7)
L_f89:
    buffer_load_dwordx4 v[204:207], v1, s[32:35], s80 offen offset:1024 nt
    s_waitcnt vmcnt(9)
    s_cmp_ge_u32 s27, 56
    s_cbranch_scc1 L_f90
    s_waitcnt vmcnt(7)
L_f90:
    buffer_load_dwordx4 v[208:211], v1, s[32:35], s80 offen offset:2048 nt
    v_dot2_f32_bf16 v50, v152, v64, 0
    v_dot2_f32_bf16 v51, v156, v64, 0
    v_dot2_f32_bf16 v52, v160, v64, 0
    v_dot2_f32_bf16 v53, v164, v64, 0
    v_dot2_f32_bf16 v50, v153, v65, v50
    v_dot2_f32_bf16 v51, v157, v65, v51
    v_dot2_f32_bf16 v52, v161, v65, v52
    v_dot2_f32_bf16 v53, v165, v65, v53
    v_dot2_f32_bf16 v50, v154, v66, v50
    v_dot2_f32_bf16 v51, v158, v66, v51
    v_dot2_f32_bf16 v52, v162, v66, v52
    v_dot2_f32_bf16 v53, v166, v66, v53
    v_dot2_f32_bf16 v50, v155, v67, v50
    v_dot2_f32_bf16 v51, v159, v67, v51
    v_dot2_f32_bf16 v52, v163, v67, v52
    v_dot2_f32_bf16 v53, v167, v67, v53
    v_add_f32_dpp v54, v50, v50 row_ror:8 row_mask:0xf bank_mask:0x3
    v_add_f32_dpp v55, v51, v51 row_ror:8 row_mask:0xf bank_mask:0x3
    s_nop 0
    v_add_f32_dpp v54, v52, v52 row_ror:8 row_mask:0xf bank_mask:0xc
    v_add_f32_dpp v55, v53, v53 row_ror:8 row_mask:0xf bank_mask:0xc
    s_nop 0
    v_add_f32_dpp v56, v54, v54 row_half_mirror row_mask:0xf bank_mask:0x5
    s_nop 1
    v_add_f32_dpp v56, v55, v55 row_half_mirror row_mask:0xf bank_mask:0xa
    s_waitcnt vmcnt(9)
    s_cmp_ge_u32 s27, 59
    s_cbranch_scc1 L_f91
    s_waitcnt vmcnt(7)
L_f91:
    buffer_load_dwordx4 v[212:215], v1, s[32:35], s80 offen offset:3072 nt
    s_add_u32 s81, s81, 73728
    buffer_load_dwordx4 a[148:151], v4, s[44:47], s81 offen offset:0
    s_mov_b32 s80, 704512
    s_waitcnt vmcnt(10)
    s_cmp_ge_u32 s27, 62
    s_cbranch_scc1 L_f92
    s_waitcnt vmcnt(8)
L_f92:
    buffer_load_dwordx4 v[216:219], v1, s[32:35], s80 offen offset:0 nt
    s_waitcnt vmcnt(10)
    s_cmp_ge_u32 s27, 66
    s_cbranch_scc1 L_f93
    s_waitcnt vmcnt(5)
L_f93:
    buffer_load_dwordx4 v[220:223], v1, s[32:35], s80 offen offset:1024 nt
    s_waitcnt vmcnt(10)
    s_cmp_ge_u32 s27, 69
    s_cbranch_scc1 L_f94
    s_waitcnt vmcnt(5)
L_f94:
    buffer_load_dwordx4 v[224:227], v1, s[32:35], s80 offen offset:2048 nt
    v_dot2_f32_bf16 v50, v184, v64, 0
    v_dot2_f32_bf16 v51, v188, v64, 0
    v_dot2_f32_bf16 v52, v192, v64, 0
    v_dot2_f32_bf16 v53, v196, v64, 0
    v_dot2_f32_bf16 v50, v185, v65, v50
    v_dot2_f32_bf16 v51, v189, v65, v51
    v_dot2_f32_bf16 v52, v193, v65, v52
    v_dot2_f32_bf16 v53, v197, v65, v53
    v_dot2_f32_bf16 v50, v186, v66, v50
    v_dot2_f32_bf16 v51, v190, v66, v51
    v_dot2_f32_bf16 v52, v194, v66, v52
    v_dot2_f32_bf16 v53, v198, v66, v53
    v_dot2_f32_bf16 v50, v187, v67, v50
    v_dot2_f32_bf16 v51, v191, v67, v51
    v_dot2_f32_bf16 v52, v195, v67, v52
    v_dot2_f32_bf16 v53, v199, v67, v53
    v_add_f32_dpp v54, v50, v50 row_ror:8 row_mask:0xf bank_mask:0x3
    v_add_f32_dpp v55, v51, v51 row_ror:8 row_mask:0xf bank_mask:0x3
    s_nop 0
    v_add_f32_dpp v54, v52, v52 row_ror:8 row_mask:0xf bank_mask:0xc
    v_add_f32_dpp v55, v53, v53 row_ror:8 row_mask:0xf bank_mask:0xc
    s_nop 0
    v_add_f32_dpp v57, v54, v54 row_half_mirror row_mask:0xf bank_mask:0x5
    s_nop 1
    v_add_f32_dpp v57, v55, v55 row_half_mirror row_mask:0xf bank_mask:0xa
    s_waitcnt vmcnt(7)
    s_cmp_ge_u32 s27, 72
    s_cbranch_scc1 L_f95
    s_waitcnt vmcnt(5)
L_f95:
    buffer_load_dwordx4 v[228:231], v1, s[32:35], s80 offen offset:3072 nt
    v_sub_u32 v48, v48, v45
    v_cmp_gt_u32 vcc, 64, v48
    s_nop 0
    s_bcnt1_i32_b64 s27, vcc
    s_add_u32 s27, s27, s23
    s_max_i32 s27, s27, 0
    s_mov_b32 s80, 786432
    s_waitcnt vmcnt(7)
    s_cmp_ge_u32 s27, 36
    s_cbranch_scc1 L_f96
    s_waitcnt vmcnt(5)
L_f96:
    buffer_load_dwordx4 v[232:235], v1, s[32:35], s80 offen offset:0 nt
    buffer_load_dwordx4 a[156:159], v4, s[44:47], s81 offen offset:128
    s_waitcnt vmcnt(8)
    s_cmp_ge_u32 s27, 39
    s_cbranch_scc1 L_f97
    s_waitcnt vmcnt(5)
L_f97:
    buffer_load_dwordx4 v[236:239], v1, s[32:35], s80 offen offset:1024 nt
    s_waitcnt vmcnt(8)
    s_cmp_ge_u32 s27, 43
    s_cbranch_scc1 L_f98
    s_waitcnt vmcnt(5)
L_f98:
    buffer_load_dwordx4 v[240:243], v1, s[32:35], s80 offen offset:2048 nt
    v_dot2_f32_bf16 v50, v200, v64, 0
    v_dot2_f32_bf16 v51, v204, v64, 0
    v_dot2_f32_bf16 v52, v208, v64, 0
    v_dot2_f32_bf16 v53, v212, v64, 0
    v_dot2_f32_bf16 v50, v201, v65, v50
    v_dot2_f32_bf16 v51, v205, v65, v51
    v_dot2_f32_bf16 v52, v209, v65, v52
    v_dot2_f32_bf16 v53, v213, v65, v53
    v_dot2_f32_bf16 v50, v202, v66, v50
    v_dot2_f32_bf16 v51, v206, v66, v51
    v_dot2_f32_bf16 v52, v210, v66, v52
    v_dot2_f32_bf16 v53, v214, v66, v53
    v_dot2_f32_bf16 v50, v203, v67, v50
    v_dot2_f32_bf16 v51, v207, v67, v51
    v_dot2_f32_bf16 v52, v211, v67, v52
    v_dot2_f32_bf16 v53, v215, v67, v53
    v_add_f32_dpp v54, v50, v50 row_ror:8 row_mask:0xf bank_mask:0x3
    v_add_f32_dpp v55, v51, v51 row_ror:8 row_mask:0xf bank_mask:0x3
    s_nop 0
    v_add_f32_dpp v54, v52, v52 row_ror:8 row_mask:0xf bank_mask:0xc
    v_add_f32_dpp v55, v53, v53 row_ror:8 row_mask:0xf bank_mask:0xc
    s_nop 0
    v_add_f32_dpp v58, v54, v54 row_half_mirror row_mask:0xf bank_mask:0x5
    s_nop 1
    v_add_f32_dpp v58, v55, v55 row_half_mirror row_mask:0xf bank_mask:0xa
    s_waitcnt vmcnt(7)
    s_cmp_ge_u32 s27, 46
    s_cbranch_scc1 L_f99
    s_waitcnt vmcnt(5)
L_f99:
    buffer_load_dwordx4 v[244:247], v1, s[32:35], s80 offen offset:3072 nt
    v_add_u32 v45, 1, v45
    buffer_store_dword v45, v46, s[68:71], 0 offen
    buffer_load_dword v48, v47, s[68:71], 0 offen nt
    s_mov_b32 s80, 802816
    s_waitcnt vmcnt(9)
    s_cmp_ge_u32 s27, 49
    s_cbranch_scc1 L_f100
    s_waitcnt vmcnt(7)
L_f100:
    buffer_load_dwordx4 v[248:251], v1, s[32:35], s80 offen offset:0 nt
    buffer_load_dwordx4 a[44:47], v6, s[52:55], 0 offen offset:0
    s_waitcnt vmcnt(10)
    s_cmp_ge_u32 s27, 52
    s_cbranch_scc1 L_f101
    s_waitcnt vmcnt(8)
L_f101:
    buffer_load_dwordx4 v[252:255], v1, s[32:35], s80 offen offset:1024 nt
    s_waitcnt vmcnt(10)
    s_cmp_ge_u32 s27, 56
    s_cbranch_scc1 L_f102
    s_waitcnt vmcnt(7)
L_f102:
    buffer_load_dwordx4 v[168:171], v1, s[32:35], s80 offen offset:2048 nt
    v_dot2_f32_bf16 v50, v216, v64, 0
    v_dot2_f32_bf16 v51, v220, v64, 0
    v_dot2_f32_bf16 v52, v224, v64, 0
    v_dot2_f32_bf16 v53, v228, v64, 0
    v_dot2_f32_bf16 v50, v217, v65, v50
    v_dot2_f32_bf16 v51, v221, v65, v51
    v_dot2_f32_bf16 v52, v225, v65, v52
    v_dot2_f32_bf16 v53, v229, v65, v53
    v_dot2_f32_bf16 v50, v218, v66, v50
    v_dot2_f32_bf16 v51, v222, v66, v51
    v_dot2_f32_bf16 v52, v226, v66, v52
    v_dot2_f32_bf16 v53, v230, v66, v53
    v_dot2_f32_bf16 v50, v219, v67, v50
    v_dot2_f32_bf16 v51, v223, v67, v51
    v_dot2_f32_bf16 v52, v227, v67, v52
    v_dot2_f32_bf16 v53, v231, v67, v53
    v_add_f32_dpp v54, v50, v50 row_ror:8 row_mask:0xf bank_mask:0x3
    v_add_f32_dpp v55, v51, v51 row_ror:8 row_mask:0xf bank_mask:0x3
    s_nop 0
    v_add_f32_dpp v54, v52, v52 row_ror:8 row_mask:0xf bank_mask:0xc
    v_add_f32_dpp v55, v53, v53 row_ror:8 row_mask:0xf bank_mask:0xc
    s_nop 0
    v_add_f32_dpp v59, v54, v54 row_half_mirror row_mask:0xf bank_mask:0x5
    s_nop 1
    v_add_f32_dpp v59, v55, v55 row_half_mirror row_mask:0xf bank_mask:0xa
    v_cndmask_b32 v50, v56, v58, s[82:83]
    v_cndmask_b32 v51, v58, v56, s[82:83]
    v_cndmask_b32 v52, v57, v59, s[82:83]
    v_cndmask_b32 v53, v59, v57, s[82:83]
    v_add_f32_dpp v54, v51, v50 quad_perm:[2,3,0,1] row_mask:0xf bank_mask:0xf
    s_nop 0
    v_add_f32_dpp v55, v53, v52 quad_perm:[2,3,0,1] row_mask:0xf bank_mask:0xf
    v_cndmask_b32 v60, v54, v55, s[84:85]
    v_cndmask_b32 v61, v55, v54, s[84:85]
    s_nop 1
    v_add_f32_dpp v33, v61, v60 quad_perm:[1,0,3,2] row_mask:0xf bank_mask:0xf
    s_waitcnt vmcnt(10)
    s_cmp_ge_u32 s27, 59
    s_cbranch_scc1 L_f103
    s_waitcnt vmcnt(7)
L_f103:
    buffer_load_dwordx4 v[172:175], v1, s[32:35], s80 offen offset:3072 nt
    s_mov_b32 s80, 819200
    s_waitcnt vmcnt(9)
    s_cmp_ge_u32 s27, 62
    s_cbranch_scc1 L_f104
    s_waitcnt vmcnt(7)
L_f104:
    buffer_load_dwordx4 v[176:179], v1, s[32:35], s80 offen offset:0 nt
    s_waitcnt vmcnt(9)
    s_cmp_ge_u32 s27, 66
    s_cbranch_scc1 L_f105
    s_waitcnt vmcnt(5)
L_f105:
    buffer_load_dwordx4 v[180:183], v1, s[32:35], s80 offen offset:1024 nt
    buffer_load_dwordx4 a[48:51], v6, s[52:55], 0 offen offset:128
    s_waitcnt vmcnt(10)
    s_cmp_ge_u32 s27, 69
    s_cbranch_scc1 L_f106
    s_waitcnt vmcnt(5)
L_f106:
    buffer_load_dwordx4 v[112:115], v1, s[32:35], s80 offen offset:2048 nt
    v_dot2_f32_bf16 v50, v232, v64, 0
    v_dot2_f32_bf16 v51, v236, v64, 0
    v_dot2_f32_bf16 v52, v240, v64, 0
    v_dot2_f32_bf16 v53, v244, v64, 0
    v_dot2_f32_bf16 v50, v233, v65, v50
    v_dot2_f32_bf16 v51, v237, v65, v51
    v_dot2_f32_bf16 v52, v241, v65, v52
    v_dot2_f32_bf16 v53, v245, v65, v53
    v_dot2_f32_bf16 v50, v234, v66, v50
    v_dot2_f32_bf16 v51, v238, v66, v51
    v_dot2_f32_bf16 v52, v242, v66, v52
    v_dot2_f32_bf16 v53, v246, v66, v53
    v_dot2_f32_bf16 v50, v235, v67, v50
    v_dot2_f32_bf16 v51, v239, v67, v51
    v_dot2_f32_bf16 v52, v243, v67, v52
    v_dot2_f32_bf16 v53, v247, v67, v53
    v_add_f32_dpp v54, v50, v50 row_ror:8 row_mask:0xf bank_mask:0x3
    v_add_f32_dpp v55, v51, v51 row_ror:8 row_mask:0xf bank_mask:0x3
    s_nop 0
    v_add_f32_dpp v54, v52, v52 row_ror:8 row_mask:0xf bank_mask:0xc
    v_add_f32_dpp v55, v53, v53 row_ror:8 row_mask:0xf bank_mask:0xc
    s_nop 0
    v_add_f32_dpp v56, v54, v54 row_half_mirror row_mask:0xf bank_mask:0x5
    s_nop 1
    v_add_f32_dpp v56, v55, v55 row_half_mirror row_mask:0xf bank_mask:0xa
    s_waitcnt vmcnt(8)
    s_cmp_ge_u32 s27, 72
    s_cbranch_scc1 L_f107
    s_waitcnt vmcnt(5)
L_f107:
    buffer_load_dwordx4 v[116:119], v1, s[32:35], s80 offen offset:3072 nt
    v_sub_u32 v48, v48, v45
    v_cmp_gt_u32 vcc, 64, v48
    s_nop 0
    s_bcnt1_i32_b64 s27, vcc
    s_add_u32 s27, s27, s23
    s_max_i32 s27, s27, 0
    s_mov_b32 s80, 835584
    s_waitcnt vmcnt(7)
    s_cmp_ge_u32 s27, 36
    s_cbranch_scc1 L_f108
    s_waitcnt vmcnt(5)
L_f108:
    buffer_load_dwordx4 v[120:123], v1, s[32:35], s80 offen offset:0 nt
    v_and_b32 v80, v36, v16
    v_and_b32 v81, v36, v17
    v_and_b32 v82, v36, v18
    v_and_b32 v83, v36, v19
    s_nop 1
    v_mfma_f32_16x16x32_bf16 v[96:99], v[80:83], a[44:47], 0
    s_waitcnt vmcnt(7)
    s_cmp_ge_u32 s27, 39
    s_cbranch_scc1 L_f109
    s_waitcnt vmcnt(5)
L_f109:
    buffer_load_dwordx4 v[124:127], v1, s[32:35], s80 offen offset:1024 nt
    buffer_load_dwordx4 a[52:55], v6, s[52:55], 0 offen offset:1152
    s_waitcnt vmcnt(8)
    s_cmp_ge_u32 s27, 43
    s_cbranch_scc1 L_f110
    s_waitcnt vmcnt(6)
L_f110:
    buffer_load_dwordx4 v[128:131], v1, s[32:35], s80 offen offset:2048 nt
    v_dot2_f32_bf16 v50, v248, v64, 0
    v_dot2_f32_bf16 v51, v252, v64, 0
    v_dot2_f32_bf16 v52, v168, v64, 0
    v_dot2_f32_bf16 v53, v172, v64, 0
    v_dot2_f32_bf16 v50, v249, v65, v50
    v_dot2_f32_bf16 v51, v253, v65, v51
    v_dot2_f32_bf16 v52, v169, v65, v52
    v_dot2_f32_bf16 v53, v173, v65, v53
    v_dot2_f32_bf16 v50, v250, v66, v50
    v_dot2_f32_bf16 v51, v254, v66, v51
    v_dot2_f32_bf16 v52, v170, v66, v52
    v_dot2_f32_bf16 v53, v174, v66, v53
    v_dot2_f32_bf16 v50, v251, v67, v50
    v_dot2_f32_bf16 v51, v255, v67, v51
    v_dot2_f32_bf16 v52, v171, v67, v52
    v_dot2_f32_bf16 v53, v175, v67, v53
    v_add_f32_dpp v54, v50, v50 row_ror:8 row_mask:0xf bank_mask:0x3
    v_add_f32_dpp v55, v51, v51 row_ror:8 row_mask:0xf bank_mask:0x3
    s_nop 0
    v_add_f32_dpp v54, v52, v52 row_ror:8 row_mask:0xf bank_mask:0xc
    v_add_f32_dpp v55, v53, v53 row_ror:8 row_mask:0xf bank_mask:0xc
    s_nop 0
    v_add_f32_dpp v57, v54, v54 row_half_mirror row_mask:0xf bank_mask:0x5
    s_nop 1
    v_add_f32_dpp v57, v55, v55 row_half_mirror row_mask:0xf bank_mask:0xa
    s_waitcnt vmcnt(8)
    s_cmp_ge_u32 s27, 46
    s_cbranch_scc1 L_f111
    s_waitcnt vmcnt(5)
L_f111:
    buffer_load_dwordx4 v[132:135], v1, s[32:35], s80 offen offset:3072 nt
    v_add_u32 v45, 1, v45
    buffer_store_dword v45, v46, s[68:71], 0 offen
    buffer_load_dword v48, v47, s[68:71], 0 offen nt
    s_mov_b32 s80, 917504
    s_waitcnt vmcnt(10)
    s_cmp_ge_u32 s27, 49
    s_cbranch_scc1 L_f112
    s_waitcnt vmcnt(7)
L_f112:
    buffer_load_dwordx4 v[136:139], v1, s[32:35], s80 offen offset:0 nt
    s_waitcnt vmcnt(9)
    s_cmp_ge_u32 s27, 52
    s_cbranch_scc1 L_f113
    s_waitcnt vmcnt(7)
L_f113:
    buffer_load_dwordx4 v[140:143], v1, s[32:35], s80 offen offset:1024 nt
    v_mfma_f32_16x16x32_bf16 v[100:103], v[80:83], a[48:51], 0
    s_waitcnt vmcnt(9)
    s_cmp_ge_u32 s27, 56
    s_cbranch_scc1 L_f114
    s_waitcnt vmcnt(7)
L_f114:
    buffer_load_dwordx4 v[144:147], v1, s[32:35], s80 offen offset:2048 nt
    v_dot2_f32_bf16 v50, v176, v64, 0
    v_dot2_f32_bf16 v51, v180, v64, 0
    v_dot2_f32_bf16 v52, v112, v64, 0
    v_dot2_f32_bf16 v53, v116, v64, 0
    v_dot2_f32_bf16 v50, v177, v65, v50
    v_dot2_f32_bf16 v51, v181, v65, v51
    v_dot2_f32_bf16 v52, v113, v65, v52
    v_dot2_f32_bf16 v53, v117, v65, v53
    v_dot2_f32_bf16 v50, v178, v66, v50
    v_dot2_f32_bf16 v51, v182, v66, v51
    v_dot2_f32_bf16 v52, v114, v66, v52
    v_dot2_f32_bf16 v53, v118, v66, v53
    v_dot2_f32_bf16 v50, v179, v67, v50
    v_dot2_f32_bf16 v51, v183, v67, v51
    v_dot2_f32_bf16 v52, v115, v67, v52
    v_dot2_f32_bf16 v53, v119, v67, v53
    v_add_f32_dpp v54, v50, v50 row_ror:8 row_mask:0xf bank_mask:0x3
    v_add_f32_dpp v55, v51, v51 row_ror:8 row_mask:0xf bank_mask:0x3
    s_nop 0
    v_add_f32_dpp v54, v52, v52 row_ror:8 row_mask:0xf bank_mask:0xc
    v_add_f32_dpp v55, v53, v53 row_ror:8 row_mask:0xf bank_mask:0xc
    s_nop 0
    v_add_f32_dpp v58, v54, v54 row_half_mirror row_mask:0xf bank_mask:0x5
    s_nop 1
    v_add_f32_dpp v58, v55, v55 row_half_mirror row_mask:0xf bank_mask:0xa
    buffer_load_dwordx4 a[56:59], v6, s[52:55], 0 offen offset:1280
    s_waitcnt vmcnt(10)
    s_cmp_ge_u32 s27, 59
    s_cbranch_scc1 L_f115
    s_waitcnt vmcnt(7)
L_f115:
    buffer_load_dwordx4 v[148:151], v1, s[32:35], s80 offen offset:3072 nt
    s_mov_b32 s80, 933888
    s_waitcnt vmcnt(10)
    s_cmp_ge_u32 s27, 62
    s_cbranch_scc1 L_f116
    s_waitcnt vmcnt(7)
L_f116:
    buffer_load_dwordx4 v[152:155], v1, s[32:35], s80 offen offset:0 nt
    s_waitcnt vmcnt(9)
    s_cmp_ge_u32 s27, 66
    s_cbranch_scc1 L_f117
    s_waitcnt vmcnt(5)
L_f117:
    buffer_load_dwordx4 v[156:159], v1, s[32:35], s80 offen offset:1024 nt
    v_and_b32 v84, v37, v16
    v_and_b32 v85, v37, v17
    v_and_b32 v86, v37, v18
    v_and_b32 v87, v37, v19
    s_nop 1
    v_mfma_f32_16x16x32_bf16 v[96:99], v[84:87], a[52:55], v[96:99]
    s_waitcnt vmcnt(9)
    s_cmp_ge_u32 s27, 69
    s_cbranch_scc1 L_f118
    s_waitcnt vmcnt(5)
L_f118:
    buffer_load_dwordx4 v[160:163], v1, s[32:35], s80 offen offset:2048 nt
    v_dot2_f32_bf16 v50, v120, v64, 0
    v_dot2_f32_bf16 v51, v124, v64, 0
    v_dot2_f32_bf16 v52, v128, v64, 0
    v_dot2_f32_bf16 v53, v132, v64, 0
    v_dot2_f32_bf16 v50, v121, v65, v50
    v_dot2_f32_bf16 v51, v125, v65, v51
    v_dot2_f32_bf16 v52, v129, v65, v52
    v_dot2_f32_bf16 v53, v133, v65, v53
    v_dot2_f32_bf16 v50, v122, v66, v50
    v_dot2_f32_bf16 v51, v126, v66, v51
    v_dot2_f32_bf16 v52, v130, v66, v52
    v_dot2_f32_bf16 v53, v134, v66, v53
    v_dot2_f32_bf16 v50, v123, v67, v50
    v_dot2_f32_bf16 v51, v127, v67, v51
    v_dot2_f32_bf16 v52, v131, v67, v52
    v_dot2_f32_bf16 v53, v135, v67, v53
    v_add_f32_dpp v54, v50, v50 row_ror:8 row_mask:0xf bank_mask:0x3
    v_add_f32_dpp v55, v51, v51 row_ror:8 row_mask:0xf bank_mask:0x3
    s_nop 0
    v_add_f32_dpp v54, v52, v52 row_ror:8 row_mask:0xf bank_mask:0xc
    v_add_f32_dpp v55, v53, v53 row_ror:8 row_mask:0xf bank_mask:0xc
    s_nop 0
    v_add_f32_dpp v59, v54, v54 row_half_mirror row_mask:0xf bank_mask:0x5
    s_nop 1
    v_add_f32_dpp v59, v55, v55 row_half_mirror row_mask:0xf bank_mask:0xa
    v_cndmask_b32 v50, v56, v58, s[82:83]
    v_cndmask_b32 v51, v58, v56, s[82:83]
    v_cndmask_b32 v52, v57, v59, s[82:83]
    v_cndmask_b32 v53, v59, v57, s[82:83]
    v_add_f32_dpp v54, v51, v50 quad_perm:[2,3,0,1] row_mask:0xf bank_mask:0xf
    s_nop 0
    v_add_f32_dpp v55, v53, v52 quad_perm:[2,3,0,1] row_mask:0xf bank_mask:0xf
    v_cndmask_b32 v60, v54, v55, s[84:85]
    v_cndmask_b32 v61, v55, v54, s[84:85]
    s_nop 1
    v_add_f32_dpp v34, v61, v60 quad_perm:[1,0,3,2] row_mask:0xf bank_mask:0xf
    buffer_load_dwordx4 a[60:63], v6, s[52:55], 0 offen offset:2304
    s_waitcnt vmcnt(8)
    s_cmp_ge_u32 s27, 72
    s_cbranch_scc1 L_f119
    s_waitcnt vmcnt(6)
L_f119:
    buffer_load_dwordx4 v[164:167], v1, s[32:35], s80 offen offset:3072 nt
    v_sub_u32 v48, v48, v45
    v_cmp_gt_u32 vcc, 64, v48
    s_nop 0
    s_bcnt1_i32_b64 s27, vcc
    s_add_u32 s27, s27, s23
    s_max_i32 s27, s27, 0
    s_mov_b32 s80, 950272
    s_waitcnt vmcnt(8)
    s_cmp_ge_u32 s27, 36
    s_cbranch_scc1 L_f120
    s_waitcnt vmcnt(5)
L_f120:
    buffer_load_dwordx4 v[184:187], v1, s[32:35], s80 offen offset:0 nt
    s_waitcnt vmcnt(8)
    s_cmp_ge_u32 s27, 39
    s_cbranch_scc1 L_f121
    s_waitcnt vmcnt(5)
L_f121:
    buffer_load_dwordx4 v[188:191], v1, s[32:35], s80 offen offset:1024 nt
    s_waitcnt vmcnt(7)
    s_cmp_ge_u32 s27, 43
    s_cbranch_scc1 L_f122
    s_waitcnt vmcnt(5)
L_f122:
    buffer_load_dwordx4 v[192:195], v1, s[32:35], s80 offen offset:2048 nt
    v_mfma_f32_16x16x32_bf16 v[100:103], v[84:87], a[56:59], v[100:103]
    v_dot2_f32_bf16 v50, v136, v64, 0
    v_dot2_f32_bf16 v51, v140, v64, 0
    v_dot2_f32_bf16 v52, v144, v64, 0
    v_dot2_f32_bf16 v53, v148, v64, 0
    v_dot2_f32_bf16 v50, v137, v65, v50
    v_dot2_f32_bf16 v51, v141, v65, v51
    v_dot2_f32_bf16 v52, v145, v65, v52
    v_dot2_f32_bf16 v53, v149, v65, v53
    v_dot2_f32_bf16 v50, v138, v66, v50
    v_dot2_f32_bf16 v51, v142, v66, v51
    v_dot2_f32_bf16 v52, v146, v66, v52
    v_dot2_f32_bf16 v53, v150, v66, v53
    v_dot2_f32_bf16 v50, v139, v67, v50
    v_dot2_f32_bf16 v51, v143, v67, v51
    v_dot2_f32_bf16 v52, v147, v67, v52
    v_dot2_f32_bf16 v53, v151, v67, v53
    v_add_f32_dpp v54, v50, v50 row_ror:8 row_mask:0xf bank_mask:0x3
    v_add_f32_dpp v55, v51, v51 row_ror:8 row_mask:0xf bank_mask:0x3
    s_nop 0
    v_add_f32_dpp v54, v52, v52 row_ror:8 row_mask:0xf bank_mask:0xc
    v_add_f32_dpp v55, v53, v53 row_ror:8 row_mask:0xf bank_mask:0xc
    s_nop 0
    v_add_f32_dpp v56, v54, v54 row_half_mirror row_mask:0xf bank_mask:0x5
    s_nop 1
    v_add_f32_dpp v56, v55, v55 row_half_mirror row_mask:0xf bank_mask:0xa
    s_waitcnt vmcnt(7)
    s_cmp_ge_u32 s27, 46
    s_cbranch_scc1 L_f123
    s_waitcnt vmcnt(5)
L_f123:
    buffer_load_dwordx4 v[196:199], v1, s[32:35], s80 offen offset:3072 nt
    v_add_u32 v45, 1, v45
    buffer_store_dword v45, v46, s[68:71], 0 offen
    buffer_load_dword v48, v47, s[68:71], 0 offen nt
    buffer_load_dwordx4 a[64:67], v6, s[52:55], 0 offen offset:2432
    s_mov_b32 s80, 966656
    s_waitcnt vmcnt(10)
    s_cmp_ge_u32 s27, 49
    s_cbranch_scc1 L_f124
    s_waitcnt vmcnt(7)
L_f124:
    buffer_load_dwordx4 v[200:203], v1, s[32:35], s80 offen offset:0 nt
    s_waitcnt vmcnt(10)
    s_cmp_ge_u32 s27, 52
    s_cbranch_scc1 L_f125
    s_waitcnt vmcnt(7)
L_f125:
    buffer_load_dwordx4 v[204:207], v1, s[32:35], s80 offen offset:1024 nt
    s_waitcnt vmcnt(9)
    s_cmp_ge_u32 s27, 56
    s_cbranch_scc1 L_f126
    s_waitcnt vmcnt(7)
L_f126:
    buffer_load_dwordx4 v[208:211], v1, s[32:35], s80 offen offset:2048 nt
    v_and_b32 v80, v38, v16
    v_and_b32 v81, v38, v17
    v_and_b32 v82, v38, v18
    v_and_b32 v83, v38, v19
    s_nop 1
    v_mfma_f32_16x16x32_bf16 v[96:99], v[80:83], a[60:63], v[96:99]
    v_dot2_f32_bf16 v50, v152, v64, 0
    v_dot2_f32_bf16 v51, v156, v64, 0
    v_dot2_f32_bf16 v52, v160, v64, 0
    v_dot2_f32_bf16 v53, v164, v64, 0
    v_dot2_f32_bf16 v50, v153, v65, v50
    v_dot2_f32_bf16 v51, v157, v65, v51
    v_dot2_f32_bf16 v52, v161, v65, v52
    v_dot2_f32_bf16 v53, v165, v65, v53
    v_dot2_f32_bf16 v50, v154, v66, v50
    v_dot2_f32_bf16 v51, v158, v66, v51
    v_dot2_f32_bf16 v52, v162, v66, v52
    v_dot2_f32_bf16 v53, v166, v66, v53
    v_dot2_f32_bf16 v50, v155, v67, v50
    v_dot2_f32_bf16 v51, v159, v67, v51
    v_dot2_f32_bf16 v52, v163, v67, v52
    v_dot2_f32_bf16 v53, v167, v67, v53
    v_add_f32_dpp v54, v50, v50 row_ror:8 row_mask:0xf bank_mask:0x3
    v_add_f32_dpp v55, v51, v51 row_ror:8 row_mask:0xf bank_mask:0x3
    s_nop 0
    v_add_f32_dpp v54, v52, v52 row_ror:8 row_mask:0xf bank_mask:0xc
    v_add_f32_dpp v55, v53, v53 row_ror:8 row_mask:0xf bank_mask:0xc
    s_nop 0
    v_add_f32_dpp v57, v54, v54 row_half_mirror row_mask:0xf bank_mask:0x5
    s_nop 1
    v_add_f32_dpp v57, v55, v55 row_half_mirror row_mask:0xf bank_mask:0xa
    s_waitcnt vmcnt(9)
    s_cmp_ge_u32 s27, 59
    s_cbranch_scc1 L_f127
    s_waitcnt vmcnt(7)
L_f127:
    buffer_load_dwordx4 v[212:215], v1, s[32:35], s80 offen offset:3072 nt
    buffer_load_dwordx4 a[68:71], v6, s[52:55], 0 offen offset:3456
    s_movk_i32 s80, 0
    s_waitcnt vmcnt(10)
    s_cmp_ge_u32 s27, 62
    s_cbranch_scc1 L_f128
    s_waitcnt vmcnt(8)
L_f128:
    buffer_load_dwordx4 v[216:219], v1, s[36:39], s80 offen offset:0 nt
    s_waitcnt vmcnt(10)
    s_cmp_ge_u32 s27, 66
    s_cbranch_scc1 L_f129
    s_waitcnt vmcnt(5)
L_f129:
    buffer_load_dwordx4 v[220:223], v1, s[36:39], s80 offen offset:1024 nt
    s_waitcnt vmcnt(10)
    s_cmp_ge_u32 s27, 69
    s_cbranch_scc1 L_f130
    s_waitcnt vmcnt(5)
L_f130:
    buffer_load_dwordx4 v[224:227], v1, s[36:39], s80 offen offset:2048 nt
    v_dot2_f32_bf16 v50, v184, v64, 0
    v_dot2_f32_bf16 v51, v188, v64, 0
    v_dot2_f32_bf16 v52, v192, v64, 0
    v_dot2_f32_bf16 v53, v196, v64, 0
    v_dot2_f32_bf16 v50, v185, v65, v50
    v_dot2_f32_bf16 v51, v189, v65, v51
    v_dot2_f32_bf16 v52, v193, v65, v52
    v_dot2_f32_bf16 v53, v197, v65, v53
    v_dot2_f32_bf16 v50, v186, v66, v50
    v_dot2_f32_bf16 v51, v190, v66, v51
    v_dot2_f32_bf16 v52, v194, v66, v52
    v_dot2_f32_bf16 v53, v198, v66, v53
    v_dot2_f32_bf16 v50, v187, v67, v50
    v_dot2_f32_bf16 v51, v191, v67, v51
    v_dot2_f32_bf16 v52, v195, v67, v52
    v_dot2_f32_bf16 v53, v199, v67, v53
    v_add_f32_dpp v54, v50, v50 row_ror:8 row_mask:0xf bank_mask:0x3
    v_add_f32_dpp v55, v51, v51 row_ror:8 row_mask:0xf bank_mask:0x3
    s_nop 0
    v_add_f32_dpp v54, v52, v52 row_ror:8 row_mask:0xf bank_mask:0xc
    v_add_f32_dpp v55, v53, v53 row_ror:8 row_mask:0xf bank_mask:0xc
    s_nop 0
    v_add_f32_dpp v58, v54, v54 row_half_mirror row_mask:0xf bank_mask:0x5
    s_nop 1
    v_add_f32_dpp v58, v55, v55 row_half_mirror row_mask:0xf bank_mask:0xa
    s_waitcnt vmcnt(7)
    s_cmp_ge_u32 s27, 72
    s_cbranch_scc1 L_f131
    s_waitcnt vmcnt(5)
L_f131:
    buffer_load_dwordx4 v[228:231], v1, s[36:39], s80 offen offset:3072 nt
    v_sub_u32 v48, v48, v45
    v_cmp_gt_u32 vcc, 64, v48
    s_nop 0
    s_bcnt1_i32_b64 s27, vcc
    s_add_u32 s27, s27, s23
    s_max_i32 s27, s27, 0
    v_mfma_f32_16x16x32_bf16 v[100:103], v[80:83], a[64:67], v[100:103]
    s_movk_i32 s80, 16384
    s_waitcnt vmcnt(7)
    s_cmp_ge_u32 s27, 36
    s_cbranch_scc1 L_f132
    s_waitcnt vmcnt(5)
L_f132:
    buffer_load_dwordx4 v[232:235], v1, s[36:39], s80 offen offset:0 nt
    buffer_load_dwordx4 a[72:75], v6, s[52:55], 0 offen offset:3584
    s_waitcnt vmcnt(8)
    s_cmp_ge_u32 s27, 39
    s_cbranch_scc1 L_f133
    s_waitcnt vmcnt(5)
L_f133:
    buffer_load_dwordx4 v[236:239], v1, s[36:39], s80 offen offset:1024 nt
    v_add_u32 v45, 1, v45
    buffer_store_dword v45, v46, s[68:71], 0 offen
    buffer_load_dword v48, v47, s[68:71], 0 offen nt
    s_waitcnt vmcnt(10)
    s_cmp_ge_u32 s27, 43
    s_cbranch_scc1 L_f134
    s_waitcnt vmcnt(7)
L_f134:
    buffer_load_dwordx4 v[240:243], v1, s[36:39], s80 offen offset:2048 nt
    v_dot2_f32_bf16 v50, v200, v64, 0
    v_dot2_f32_bf16 v51, v204, v64, 0
    v_dot2_f32_bf16 v52, v208, v64, 0
    v_dot2_f32_bf16 v53, v212, v64, 0
    v_dot2_f32_bf16 v50, v201, v65, v50
    v_dot2_f32_bf16 v51, v205, v65, v51
    v_dot2_f32_bf16 v52, v209, v65, v52
    v_dot2_f32_bf16 v53, v213, v65, v53
    v_dot2_f32_bf16 v50, v202, v66, v50
    v_dot2_f32_bf16 v51, v206, v66, v51
    v_dot2_f32_bf16 v52, v210, v66, v52
    v_dot2_f32_bf16 v53, v214, v66, v53
    v_dot2_f32_bf16 v50, v203, v67, v50
    v_dot2_f32_bf16 v51, v207, v67, v51
    v_dot2_f32_bf16 v52, v211, v67, v52
    v_dot2_f32_bf16 v53, v215, v67, v53
    v_add_f32_dpp v54, v50, v50 row_ror:8 row_mask:0xf bank_mask:0x3
    v_add_f32_dpp v55, v51, v51 row_ror:8 row_mask:0xf bank_mask:0x3
    s_nop 0
    v_add_f32_dpp v54, v52, v52 row_ror:8 row_mask:0xf bank_mask:0xc
    v_add_f32_dpp v55, v53, v53 row_ror:8 row_mask:0xf bank_mask:0xc
    s_nop 0
    v_add_f32_dpp v59, v54, v54 row_half_mirror row_mask:0xf bank_mask:0x5
    s_nop 1
    v_add_f32_dpp v59, v55, v55 row_half_mirror row_mask:0xf bank_mask:0xa
    v_cndmask_b32 v50, v56, v58, s[82:83]
    v_cndmask_b32 v51, v58, v56, s[82:83]
    v_cndmask_b32 v52, v57, v59, s[82:83]
    v_cndmask_b32 v53, v59, v57, s[82:83]
    v_add_f32_dpp v54, v51, v50 quad_perm:[2,3,0,1] row_mask:0xf bank_mask:0xf
    s_nop 0
    v_add_f32_dpp v55, v53, v52 quad_perm:[2,3,0,1] row_mask:0xf bank_mask:0xf
    v_cndmask_b32 v60, v54, v55, s[84:85]
    v_cndmask_b32 v61, v55, v54, s[84:85]
    s_nop 1
    v_add_f32_dpp v35, v61, v60 quad_perm:[1,0,3,2] row_mask:0xf bank_mask:0xf
    v_max3_f32 v13, v28, v29, v30
    v_max3_f32 v13, v13, v31, v32
    v_max3_f32 v13, v13, v33, v34
    v_max_f32 v13, v13, v35
    s_nop 1
    v_max_f32_dpp v13, v13, v13 row_ror:8 row_mask:0xf bank_mask:0xf
    s_nop 1
    v_max_f32_dpp v13, v13, v13 row_ror:4 row_mask:0xf bank_mask:0xf
    s_nop 1
    v_max_f32_dpp v13, v13, v13 row_ror:2 row_mask:0xf bank_mask:0xf
    s_nop 1
    v_max_f32_dpp v13, v13, v13 row_ror:1 row_mask:0xf bank_mask:0xf
    v_mov_b32 v60, v13
    s_nop 1
    v_permlane16_swap_b32 v13, v60
    v_max_f32 v13, v13, v60
    v_mov_b32 v60, v13
    s_nop 1
    v_permlane32_swap_b32 v13, v60
    v_max_f32 v13, v13, v60
    v_mul_f32 v13, s89, v13
    s_waitcnt vmcnt(9)
    s_cmp_ge_u32 s27, 46
    s_cbranch_scc1 L_f135
    s_waitcnt vmcnt(7)
L_f135:
    buffer_load_dwordx4 v[244:247], v1, s[36:39], s80 offen offset:3072 nt
    v_and_b32 v84, v39, v16
    v_and_b32 v85, v39, v17
    v_and_b32 v86, v39, v18
    v_and_b32 v87, v39, v19
    s_nop 1
    v_mfma_f32_16x16x32_bf16 v[96:99], v[84:87], a[68:71], v[96:99]
    v_fma_f32 v28, v28, s89, -v13
    v_fma_f32 v29, v29, s89, -v13
    v_fma_f32 v30, v30, s89, -v13
    v_fma_f32 v31, v31, s89, -v13
    v_fma_f32 v32, v32, s89, -v13
    v_fma_f32 v33, v33, s89, -v13
    v_fma_f32 v34, v34, s89, -v13
    v_fma_f32 v35, v35, s89, -v13
    v_exp_f32 v28, v28
    v_exp_f32 v29, v29
    v_exp_f32 v30, v30
    v_exp_f32 v31, v31
    v_exp_f32 v32, v32
    v_exp_f32 v33, v33
    v_exp_f32 v34, v34
    v_exp_f32 v35, v35
    v_add_f32 v57, v28, v29
    v_add_f32 v57, v57, v30
    v_add_f32 v57, v57, v31
    v_add_f32 v57, v57, v32
    v_add_f32 v57, v57, v33
    v_add_f32 v57, v57, v34
    v_add_f32 v57, v57, v35
    v_cvt_pk_bf16_f32 v28, v28, v28
    v_cvt_pk_bf16_f32 v29, v29, v29
    v_cvt_pk_bf16_f32 v30, v30, v30
    v_cvt_pk_bf16_f32 v31, v31, v31
    v_cvt_pk_bf16_f32 v32, v32, v32
    v_cvt_pk_bf16_f32 v33, v33, v33
    v_cvt_pk_bf16_f32 v34, v34, v34
    v_cvt_pk_bf16_f32 v35, v35, v35
    s_mov_b32 s80, 32768
    s_waitcnt vmcnt(9)
    s_cmp_ge_u32 s27, 49
    s_cbranch_scc1 L_f136
    s_waitcnt vmcnt(7)
L_f136:
    buffer_load_dwordx4 v[248:251], v1, s[36:39], s80 offen offset:0 nt
    v_add_f32_dpp v57, v57, v57 row_ror:8 row_mask:0xf bank_mask:0xf
    s_nop 1
    v_add_f32_dpp v57, v57, v57 row_ror:4 row_mask:0xf bank_mask:0xf
    s_nop 1
    v_add_f32_dpp v57, v57, v57 row_ror:2 row_mask:0xf bank_mask:0xf
    s_nop 1
    v_add_f32_dpp v57, v57, v57 row_ror:1 row_mask:0xf bank_mask:0xf
    v_mov_b32 v60, v57
    s_nop 1
    v_permlane16_swap_b32 v57, v60
    v_add_f32 v57, v57, v60
    v_mov_b32 v60, v57
    s_nop 1
    v_permlane32_swap_b32 v57, v60
    v_add_f32 v57, v57, v60
    v_mov_b32 v56, v13
    v_mov_b32 v58, s95
    v_mov_b32 v59, 1
    ds_write_b128 v110, v[56:59] offset:8192
    v_and_b32 v110, 3, v0
    v_lshlrev_b32 v110, 4, v110
    buffer_load_dwordx4 a[76:79], v7, s[52:55], 0 offen offset:0
    v_and_b32_dpp v72, v28, v16 row_newbcast:0 row_mask:0xf bank_mask:0xf
    v_and_b32_dpp v73, v28, v17 row_newbcast:0 row_mask:0xf bank_mask:0xf
    v_and_b32_dpp v74, v28, v18 row_newbcast:0 row_mask:0xf bank_mask:0xf
    v_and_b32_dpp v75, v28, v19 row_newbcast:0 row_mask:0xf bank_mask:0xf
    s_nop 1
    v_mfma_f32_16x16x32_bf16 v[68:71], v[72:75], v[216:219], 0
    v_and_b32_dpp v76, v28, v16 row_newbcast:4 row_mask:0xf bank_mask:0xf
    v_and_b32_dpp v77, v28, v17 row_newbcast:4 row_mask:0xf bank_mask:0xf
    v_and_b32_dpp v78, v28, v18 row_newbcast:4 row_mask:0xf bank_mask:0xf
    v_and_b32_dpp v79, v28, v19 row_newbcast:4 row_mask:0xf bank_mask:0xf
    s_nop 1
    v_mfma_f32_16x16x32_bf16 v[68:71], v[76:79], v[220:223], v[68:71]
    v_and_b32_dpp v72, v28, v16 row_newbcast:8 row_mask:0xf bank_mask:0xf
    v_and_b32_dpp v73, v28, v17 row_newbcast:8 row_mask:0xf bank_mask:0xf
    v_and_b32_dpp v74, v28, v18 row_newbcast:8 row_mask:0xf bank_mask:0xf
    v_and_b32_dpp v75, v28, v19 row_newbcast:8 row_mask:0xf bank_mask:0xf
    s_waitcnt vmcnt(10)
    s_cmp_ge_u32 s27, 52
    s_cbranch_scc1 L_f137
    s_waitcnt vmcnt(8)
L_f137:
    buffer_load_dwordx4 v[252:255], v1, s[36:39], s80 offen offset:1024 nt
    v_mfma_f32_16x16x32_bf16 v[68:71], v[72:75], v[224:227], v[68:71]
    v_and_b32_dpp v76, v28, v16 row_newbcast:12 row_mask:0xf bank_mask:0xf
    v_and_b32_dpp v77, v28, v17 row_newbcast:12 row_mask:0xf bank_mask:0xf
    v_and_b32_dpp v78, v28, v18 row_newbcast:12 row_mask:0xf bank_mask:0xf
    v_and_b32_dpp v79, v28, v19 row_newbcast:12 row_mask:0xf bank_mask:0xf
    s_waitcnt vmcnt(10)
    s_cmp_ge_u32 s27, 56
    s_cbranch_scc1 L_f138
    s_waitcnt vmcnt(7)
L_f138:
    buffer_load_dwordx4 v[168:171], v1, s[36:39], s80 offen offset:2048 nt
    v_mfma_f32_16x16x32_bf16 v[68:71], v[76:79], v[228:231], v[68:71]
    v_and_b32_dpp v72, v28, v16 row_newbcast:1 row_mask:0xf bank_mask:0xf
    v_and_b32_dpp v73, v28, v17 row_newbcast:1 row_mask:0xf bank_mask:0xf
    v_and_b32_dpp v74, v28, v18 row_newbcast:1 row_mask:0xf bank_mask:0xf
    v_and_b32_dpp v75, v28, v19 row_newbcast:1 row_mask:0xf bank_mask:0xf
    s_waitcnt vmcnt(10)
    s_cmp_ge_u32 s27, 59
    s_cbranch_scc1 L_f139
    s_waitcnt vmcnt(5)
L_f139:
    buffer_load_dwordx4 v[172:175], v1, s[36:39], s80 offen offset:3072 nt
    v_mfma_f32_16x16x32_bf16 v[68:71], v[72:75], v[232:235], v[68:71]
    v_and_b32_dpp v76, v28, v16 row_newbcast:5 row_mask:0xf bank_mask:0xf
    v_and_b32_dpp v77, v28, v17 row_newbcast:5 row_mask:0xf bank_mask:0xf
    v_and_b32_dpp v78, v28, v18 row_newbcast:5 row_mask:0xf bank_mask:0xf
    v_and_b32_dpp v79, v28, v19 row_newbcast:5 row_mask:0xf bank_mask:0xf
    s_mov_b32 s80, 49152
    s_waitcnt vmcnt(9)
    s_cmp_ge_u32 s27, 62
    s_cbranch_scc1 L_f140
    s_waitcnt vmcnt(5)
L_f140:
    buffer_load_dwordx4 v[176:179], v1, s[36:39], s80 offen offset:0 nt
    v_mfma_f32_16x16x32_bf16 v[100:103], v[84:87], a[72:75], v[100:103]
    v_mfma_f32_16x16x32_bf16 v[68:71], v[76:79], v[236:239], v[68:71]
    v_and_b32_dpp v72, v28, v16 row_newbcast:9 row_mask:0xf bank_mask:0xf
    v_and_b32_dpp v73, v28, v17 row_newbcast:9 row_mask:0xf bank_mask:0xf
    v_and_b32_dpp v74, v28, v18 row_newbcast:9 row_mask:0xf bank_mask:0xf
    v_and_b32_dpp v75, v28, v19 row_newbcast:9 row_mask:0xf bank_mask:0xf
    buffer_load_dwordx4 a[80:83], v7, s[52:55], 0 offen offset:128
    s_waitcnt vmcnt(8)
    s_cmp_ge_u32 s27, 66
    s_cbranch_scc1 L_f141
    s_waitcnt vmcnt(6)
L_f141:
    buffer_load_dwordx4 v[180:183], v1, s[36:39], s80 offen offset:1024 nt
    v_subrev_u32 v48, s95, v48
    v_and_b32 v48, 0xfffff0ff, v48
    v_subrev_u32 v48, 11, v48
    v_cmp_gt_u32 vcc, 64, v48
    s_nop 0
    s_bcnt1_i32_b64 s27, vcc
    s_add_u32 s27, s27, s23
    s_max_i32 s27, s27, 0
    v_mfma_f32_16x16x32_bf16 v[68:71], v[72:75], v[240:243], v[68:71]
    v_and_b32_dpp v76, v28, v16 row_newbcast:13 row_mask:0xf bank_mask:0xf
    v_and_b32_dpp v77, v28, v17 row_newbcast:13 row_mask:0xf bank_mask:0xf
    v_and_b32_dpp v78, v28, v18 row_newbcast:13 row_mask:0xf bank_mask:0xf
    v_and_b32_dpp v79, v28, v19 row_newbcast:13 row_mask:0xf bank_mask:0xf
    s_waitcnt vmcnt(8)
    s_cmp_ge_u32 s27, 36
    s_cbranch_scc1 L_f142
    s_waitcnt vmcnt(5)
L_f142:
    buffer_load_dwordx4 v[112:115], v1, s[36:39], s80 offen offset:2048 nt
    ds_read_b128 v[56:59], v110 offset:8192
    s_waitcnt lgkmcnt(0)
    s_mov_b32 s92, 0x40000
L_sp:
    v_cmp_ne_u32 vcc, 1, v59
    s_cbranch_vccz L_sp_ok
    s_sub_u32 s92, s92, 1
    s_cbranch_scc1 L_sp_ok
    s_sleep 1
    ds_read_b128 v[56:59], v110 offset:8192
    s_waitcnt lgkmcnt(0)
    s_branch L_sp
L_sp_ok:
    v_not_b32 v59, v58
    buffer_store_dwordx4 v[56:59], v63, s[68:71], 0 offen sc1
    v_lshlrev_b32 v60, 2, v0
    v_xor_b32 v60, s14, v60
    v_lshlrev_b32 v60, 6, v60
    v_add_u32 v60, 0x90008, v60
    v_add_u32 v61, -1, v0
    s_lshl_b32 s90, s3, 6
    v_or_b32 v61, s90, v61
    v_cmp_gt_u32 vcc, 7, v61
    s_nop 1
    v_cndmask_b32 v60, v15, v60, vcc
    buffer_load_dword v42, v60, s[68:71], 0 offen
    v_mfma_f32_16x16x32_bf16 v[68:71], v[76:79], v[244:247], v[68:71]
    v_and_b32_dpp v72, v28, v16 row_newbcast:2 row_mask:0xf bank_mask:0xf
    v_and_b32_dpp v73, v28, v17 row_newbcast:2 row_mask:0xf bank_mask:0xf
    v_and_b32_dpp v74, v28, v18 row_newbcast:2 row_mask:0xf bank_mask:0xf
    v_and_b32_dpp v75, v28, v19 row_newbcast:2 row_mask:0xf bank_mask:0xf
    s_waitcnt vmcnt(10)
    s_cmp_ge_u32 s27, 39
    s_cbranch_scc1 L_f143
    s_waitcnt vmcnt(7)
L_f143:
    buffer_load_dwordx4 v[116:119], v1, s[36:39], s80 offen offset:3072 nt
    v_add_u32 v45, 1, v45
    buffer_store_dword v45, v46, s[68:71], 0 offen
    buffer_load_dword v48, v47, s[68:71], 0 offen nt
    v_mfma_f32_16x16x32_bf16 v[68:71], v[72:75], v[248:251], v[68:71]
    v_and_b32_dpp v76, v28, v16 row_newbcast:6 row_mask:0xf bank_mask:0xf
    v_and_b32_dpp v77, v28, v17 row_newbcast:6 row_mask:0xf bank_mask:0xf
    v_and_b32_dpp v78, v28, v18 row_newbcast:6 row_mask:0xf bank_mask:0xf
    v_and_b32_dpp v79, v28, v19 row_newbcast:6 row_mask:0xf bank_mask:0xf
    s_mov_b32 s80, 131072
    s_waitcnt vmcnt(11)
    s_cmp_ge_u32 s27, 43
    s_cbranch_scc1 L_f144
    s_waitcnt vmcnt(9)
L_f144:
    buffer_load_dwordx4 v[120:123], v1, s[36:39], s80 offen offset:0 nt
    v_and_b32 v80, v40, v16
    v_and_b32 v81, v40, v17
    v_and_b32 v82, v40, v18
    v_and_b32 v83, v40, v19
    s_nop 1
    v_mfma_f32_16x16x32_bf16 v[96:99], v[80:83], a[76:79], v[96:99]
    v_mfma_f32_16x16x32_bf16 v[68:71], v[76:79], v[252:255], v[68:71]
    v_and_b32_dpp v72, v28, v16 row_newbcast:10 row_mask:0xf bank_mask:0xf
    v_and_b32_dpp v73, v28, v17 row_newbcast:10 row_mask:0xf bank_mask:0xf
    v_and_b32_dpp v74, v28, v18 row_newbcast:10 row_mask:0xf bank_mask:0xf
    v_and_b32_dpp v75, v28, v19 row_newbcast:10 row_mask:0xf bank_mask:0xf
    s_waitcnt vmcnt(11)
    s_cmp_ge_u32 s27, 46
    s_cbranch_scc1 L_f145
    s_waitcnt vmcnt(9)
L_f145:
    buffer_load_dwordx4 v[124:127], v1, s[36:39], s80 offen offset:1024 nt
    v_mfma_f32_16x16x32_bf16 v[68:71], v[72:75], v[168:171], v[68:71]
    v_and_b32_dpp v76, v28, v16 row_newbcast:14 row_mask:0xf bank_mask:0xf
    v_and_b32_dpp v77, v28, v17 row_newbcast:14 row_mask:0xf bank_mask:0xf
    v_and_b32_dpp v78, v28, v18 row_newbcast:14 row_mask:0xf bank_mask:0xf
    v_and_b32_dpp v79, v28, v19 row_newbcast:14 row_mask:0xf bank_mask:0xf
    buffer_load_dwordx4 a[84:87], v9, s[52:55], 0 offen offset:0
    s_waitcnt vmcnt(12)
    s_cmp_ge_u32 s27, 49
    s_cbranch_scc1 L_f146
    s_waitcnt vmcnt(9)
L_f146:
    buffer_load_dwordx4 v[128:131], v1, s[36:39], s80 offen offset:2048 nt
    v_mfma_f32_16x16x32_bf16 v[68:71], v[76:79], v[172:175], v[68:71]
    v_and_b32_dpp v72, v28, v16 row_newbcast:3 row_mask:0xf bank_mask:0xf
    v_and_b32_dpp v73, v28, v17 row_newbcast:3 row_mask:0xf bank_mask:0xf
    v_and_b32_dpp v74, v28, v18 row_newbcast:3 row_mask:0xf bank_mask:0xf
    v_and_b32_dpp v75, v28, v19 row_newbcast:3 row_mask:0xf bank_mask:0xf
    s_waitcnt vmcnt(12)
    s_cmp_ge_u32 s27, 52
    s_cbranch_scc1 L_f147
    s_waitcnt vmcnt(9)
L_f147:
    buffer_load_dwordx4 v[132:135], v1, s[36:39], s80 offen offset:3072 nt
    v_mfma_f32_16x16x32_bf16 v[68:71], v[72:75], v[176:179], v[68:71]
    v_and_b32_dpp v76, v28, v16 row_newbcast:7 row_mask:0xf bank_mask:0xf
    v_and_b32_dpp v77, v28, v17 row_newbcast:7 row_mask:0xf bank_mask:0xf
    v_and_b32_dpp v78, v28, v18 row_newbcast:7 row_mask:0xf bank_mask:0xf
    v_and_b32_dpp v79, v28, v19 row_newbcast:7 row_mask:0xf bank_mask:0xf
    s_mov_b32 s80, 147456
    s_waitcnt vmcnt(11)
    s_cmp_ge_u32 s27, 56
    s_cbranch_scc1 L_f148
    s_waitcnt vmcnt(7)
L_f148:
    buffer_load_dwordx4 v[136:139], v1, s[36:39], s80 offen offset:0 nt
    v_mfma_f32_16x16x32_bf16 v[100:103], v[80:83], a[80:83], v[100:103]
    v_mfma_f32_16x16x32_bf16 v[68:71], v[76:79], v[180:183], v[68:71]
    v_and_b32_dpp v72, v28, v16 row_newbcast:11 row_mask:0xf bank_mask:0xf
    v_and_b32_dpp v73, v28, v17 row_newbcast:11 row_mask:0xf bank_mask:0xf
    v_and_b32_dpp v74, v28, v18 row_newbcast:11 row_mask:0xf bank_mask:0xf
    v_and_b32_dpp v75, v28, v19 row_newbcast:11 row_mask:0xf bank_mask:0xf
    s_waitcnt vmcnt(11)
    s_cmp_ge_u32 s27, 59
    s_cbranch_scc1 L_f149
    s_waitcnt vmcnt(5)
L_f149:
    buffer_load_dwordx4 v[140:143], v1, s[36:39], s80 offen offset:1024 nt
    v_mfma_f32_16x16x32_bf16 v[68:71], v[72:75], v[112:115], v[68:71]
    v_and_b32_dpp v76, v28, v16 row_newbcast:15 row_mask:0xf bank_mask:0xf
    v_and_b32_dpp v77, v28, v17 row_newbcast:15 row_mask:0xf bank_mask:0xf
    v_and_b32_dpp v78, v28, v18 row_newbcast:15 row_mask:0xf bank_mask:0xf
    v_and_b32_dpp v79, v28, v19 row_newbcast:15 row_mask:0xf bank_mask:0xf
    buffer_load_dwordx4 a[88:91], v8, s[52:55], 0 offen offset:0
    s_waitcnt vmcnt(10)
    s_cmp_ge_u32 s27, 62
    s_cbranch_scc1 L_f150
    s_waitcnt vmcnt(6)
L_f150:
    buffer_load_dwordx4 v[144:147], v1, s[36:39], s80 offen offset:2048 nt
    v_cmp_eq_u32 vcc, s95, v42
    s_nop 0
    s_and_b32 s22, vcc_lo, 0xfe
    s_bcnt1_i32_b32 s22, s22
    s_add_u32 s22, s22, 1
    s_lshl_b32 s25, s22, 8
    v_add_u32 v43, s25, v45
    buffer_store_dword v43, v46, s[68:71], 0 offen
    v_mfma_f32_16x16x32_bf16 v[68:71], v[76:79], v[116:119], v[68:71]
    v_and_b32_dpp v72, v29, v16 row_newbcast:0 row_mask:0xf bank_mask:0xf
    v_and_b32_dpp v73, v29, v17 row_newbcast:0 row_mask:0xf bank_mask:0xf
    v_and_b32_dpp v74, v29, v18 row_newbcast:0 row_mask:0xf bank_mask:0xf
    v_and_b32_dpp v75, v29, v19 row_newbcast:0 row_mask:0xf bank_mask:0xf
    s_waitcnt vmcnt(9)
    s_cmp_ge_u32 s27, 66
    s_cbranch_scc1 L_f151
    s_waitcnt vmcnt(6)
L_f151:
    buffer_load_dwordx4 v[148:151], v1, s[36:39], s80 offen offset:3072 nt
    v_subrev_u32 v48, s95, v48
    v_and_b32 v48, 0xfffff0ff, v48
    v_subrev_u32 v48, 12, v48
    v_cmp_gt_u32 vcc, 64, v48
    s_nop 0
    s_bcnt1_i32_b64 s27, vcc
    s_add_u32 s27, s27, s23
    s_max_i32 s27, s27, 0
    v_mfma_f32_16x16x32_bf16 v[68:71], v[72:75], v[120:123], v[68:71]
    v_and_b32_dpp v76, v29, v16 row_newbcast:4 row_mask:0xf bank_mask:0xf
    v_and_b32_dpp v77, v29, v17 row_newbcast:4 row_mask:0xf bank_mask:0xf
    v_and_b32_dpp v78, v29, v18 row_newbcast:4 row_mask:0xf bank_mask:0xf
    v_and_b32_dpp v79, v29, v19 row_newbcast:4 row_mask:0xf bank_mask:0xf
    s_mov_b32 s80, 163840
    s_waitcnt vmcnt(9)
    s_cmp_ge_u32 s27, 36
    s_cbranch_scc1 L_f152
    s_waitcnt vmcnt(6)
L_f152:
    buffer_load_dwordx4 v[152:155], v1, s[36:39], s80 offen offset:0 nt
    v_mfma_f32_16x16x32_bf16 v[68:71], v[76:79], v[124:127], v[68:71]
    v_and_b32_dpp v72, v29, v16 row_newbcast:8 row_mask:0xf bank_mask:0xf
    v_and_b32_dpp v73, v29, v17 row_newbcast:8 row_mask:0xf bank_mask:0xf
    v_and_b32_dpp v74, v29, v18 row_newbcast:8 row_mask:0xf bank_mask:0xf
    v_and_b32_dpp v75, v29, v19 row_newbcast:8 row_mask:0xf bank_mask:0xf
    s_waitcnt vmcnt(8)
    s_cmp_ge_u32 s27, 39
    s_cbranch_scc1 L_f153
    s_waitcnt vmcnt(6)
L_f153:
    buffer_load_dwordx4 v[156:159], v1, s[36:39], s80 offen offset:1024 nt
    v_add_u32 v45, 1, v45
    v_add_u32 v43, s25, v45
    buffer_store_dword v43, v46, s[68:71], 0 offen
    buffer_load_dword v48, v47, s[68:71], 0 offen nt
    v_mfma_f32_16x16x32_bf16 v[104:107], v[80:83], a[84:87], 0
    v_mfma_f32_16x16x32_bf16 v[68:71], v[72:75], v[128:131], v[68:71]
    v_and_b32_dpp v76, v29, v16 row_newbcast:12 row_mask:0xf bank_mask:0xf
    v_and_b32_dpp v77, v29, v17 row_newbcast:12 row_mask:0xf bank_mask:0xf
    v_and_b32_dpp v78, v29, v18 row_newbcast:12 row_mask:0xf bank_mask:0xf
    v_and_b32_dpp v79, v29, v19 row_newbcast:12 row_mask:0xf bank_mask:0xf
    s_waitcnt vmcnt(10)
    s_cmp_ge_u32 s27, 43
    s_cbranch_scc1 L_f154
    s_waitcnt vmcnt(8)
L_f154:
    buffer_load_dwordx4 v[160:163], v1, s[36:39], s80 offen offset:2048 nt
    v_mfma_f32_16x16x32_bf16 v[68:71], v[76:79], v[132:135], v[68:71]
    v_and_b32_dpp v72, v29, v16 row_newbcast:1 row_mask:0xf bank_mask:0xf
    v_and_b32_dpp v73, v29, v17 row_newbcast:1 row_mask:0xf bank_mask:0xf
    v_and_b32_dpp v74, v29, v18 row_newbcast:1 row_mask:0xf bank_mask:0xf
    v_and_b32_dpp v75, v29, v19 row_newbcast:1 row_mask:0xf bank_mask:0xf
    s_lshl1_add_u32 s81, s3, 3
    s_and_b32 s81, s81, 7
    s_mulk_i32 s81, 4608
    buffer_load_dwordx4 a[160:163], v4, s[44:47], s81 offen offset:0
    s_waitcnt vmcnt(11)
    s_cmp_ge_u32 s27, 46
    s_cbranch_scc1 L_f155
    s_waitcnt vmcnt(8)
L_f155:
    buffer_load_dwordx4 v[164:167], v1, s[36:39], s80 offen offset:3072 nt
    v_mfma_f32_16x16x32_bf16 v[68:71], v[72:75], v[136:139], v[68:71]
    v_and_b32_dpp v76, v29, v16 row_newbcast:5 row_mask:0xf bank_mask:0xf
    v_and_b32_dpp v77, v29, v17 row_newbcast:5 row_mask:0xf bank_mask:0xf
    v_and_b32_dpp v78, v29, v18 row_newbcast:5 row_mask:0xf bank_mask:0xf
    v_and_b32_dpp v79, v29, v19 row_newbcast:5 row_mask:0xf bank_mask:0xf
    s_mov_b32 s80, 180224
    s_waitcnt vmcnt(11)
    s_cmp_ge_u32 s27, 49
    s_cbranch_scc1 L_f156
    s_waitcnt vmcnt(7)
L_f156:
    buffer_load_dwordx4 v[184:187], v1, s[36:39], s80 offen offset:0 nt
    v_mfma_f32_16x16x32_bf16 v[68:71], v[76:79], v[140:143], v[68:71]
    v_and_b32_dpp v72, v29, v16 row_newbcast:9 row_mask:0xf bank_mask:0xf
    v_and_b32_dpp v73, v29, v17 row_newbcast:9 row_mask:0xf bank_mask:0xf
    v_and_b32_dpp v74, v29, v18 row_newbcast:9 row_mask:0xf bank_mask:0xf
    v_and_b32_dpp v75, v29, v19 row_newbcast:9 row_mask:0xf bank_mask:0xf
    s_waitcnt vmcnt(10)
    s_cmp_ge_u32 s27, 52
    s_cbranch_scc1 L_f157
    s_waitcnt vmcnt(7)
L_f157:
    buffer_load_dwordx4 v[188:191], v1, s[36:39], s80 offen offset:1024 nt
    v_and_b32 v84, v41, v16
    v_and_b32 v85, v41, v17
    v_and_b32 v86, v41, v18
    v_and_b32 v87, v41, v19
    s_nop 1
    v_mfma_f32_16x16x32_bf16 v[104:107], v[84:87], a[88:91], v[104:107]
    v_mfma_f32_16x16x32_bf16 v[68:71], v[72:75], v[144:147], v[68:71]
    v_and_b32_dpp v76, v29, v16 row_newbcast:13 row_mask:0xf bank_mask:0xf
    v_and_b32_dpp v77, v29, v17 row_newbcast:13 row_mask:0xf bank_mask:0xf
    v_and_b32_dpp v78, v29, v18 row_newbcast:13 row_mask:0xf bank_mask:0xf
    v_and_b32_dpp v79, v29, v19 row_newbcast:13 row_mask:0xf bank_mask:0xf
    s_waitcnt vmcnt(9)
    s_cmp_ge_u32 s27, 56
    s_cbranch_scc1 L_f158
    s_waitcnt vmcnt(7)
L_f158:
    buffer_load_dwordx4 v[192:195], v1, s[36:39], s80 offen offset:2048 nt
    v_mfma_f32_16x16x32_bf16 v[68:71], v[76:79], v[148:151], v[68:71]
    v_and_b32_dpp v72, v29, v16 row_newbcast:2 row_mask:0xf bank_mask:0xf
    v_and_b32_dpp v73, v29, v17 row_newbcast:2 row_mask:0xf bank_mask:0xf
    v_and_b32_dpp v74, v29, v18 row_newbcast:2 row_mask:0xf bank_mask:0xf
    v_and_b32_dpp v75, v29, v19 row_newbcast:2 row_mask:0xf bank_mask:0xf
    buffer_load_dwordx4 a[168:171], v4, s[44:47], s81 offen offset:128
    s_waitcnt vmcnt(10)
    s_cmp_ge_u32 s27, 59
    s_cbranch_scc1 L_f159
    s_waitcnt vmcnt(6)
L_f159:
    buffer_load_dwordx4 v[196:199], v1, s[36:39], s80 offen offset:3072 nt
    v_mfma_f32_16x16x32_bf16 v[68:71], v[72:75], v[152:155], v[68:71]
    v_and_b32_dpp v76, v29, v16 row_newbcast:6 row_mask:0xf bank_mask:0xf
    v_and_b32_dpp v77, v29, v17 row_newbcast:6 row_mask:0xf bank_mask:0xf
    v_and_b32_dpp v78, v29, v18 row_newbcast:6 row_mask:0xf bank_mask:0xf
    v_and_b32_dpp v79, v29, v19 row_newbcast:6 row_mask:0xf bank_mask:0xf
    s_mov_b32 s80, 262144
    s_waitcnt vmcnt(10)
    s_cmp_ge_u32 s27, 62
    s_cbranch_scc1 L_f160
    s_waitcnt vmcnt(5)
L_f160:
    buffer_load_dwordx4 v[200:203], v1, s[36:39], s80 offen offset:0 nt
    v_mfma_f32_16x16x32_bf16 v[68:71], v[76:79], v[156:159], v[68:71]
    v_and_b32_dpp v72, v29, v16 row_newbcast:10 row_mask:0xf bank_mask:0xf
    v_and_b32_dpp v73, v29, v17 row_newbcast:10 row_mask:0xf bank_mask:0xf
    v_and_b32_dpp v74, v29, v18 row_newbcast:10 row_mask:0xf bank_mask:0xf
    v_and_b32_dpp v75, v29, v19 row_newbcast:10 row_mask:0xf bank_mask:0xf
    s_waitcnt vmcnt(8)
    s_cmp_ge_u32 s27, 66
    s_cbranch_scc1 L_f161
    s_waitcnt vmcnt(5)
L_f161:
    buffer_load_dwordx4 v[204:207], v1, s[36:39], s80 offen offset:1024 nt
    v_subrev_u32 v48, s95, v48
    v_lshrrev_b32 v60, 8, v48
    v_add_u32 v60, -1, v60
    v_cmp_gt_u32 vcc, 8, v60
    v_lshl_add_u32 v60, v60, 1, -7
    s_nop 0
    v_cndmask_b32 v60, 0, v60, vcc
    s_nop 1
    v_add_u32_dpp v60, v60, v60 row_ror:8 row_mask:0xf bank_mask:0xf
    s_nop 1
    v_add_u32_dpp v60, v60, v60 row_ror:4 row_mask:0xf bank_mask:0xf
    s_nop 1
    v_add_u32_dpp v60, v60, v60 row_ror:2 row_mask:0xf bank_mask:0xf
    s_nop 1
    v_add_u32_dpp v60, v60, v60 row_ror:1 row_mask:0xf bank_mask:0xf
    s_nop 0
    v_readlane_b32 s22, v60, 0
    v_readlane_b32 s90, v60, 16
    s_nop 0
    s_add_i32 s22, s22, s90
    s_mul_i32 s22, s22, 8
    s_ashr_i32 s22, s22, 6
    s_add_i32 s23, s23, s22
    v_and_b32 v48, 0xfffff0ff, v48
    v_subrev_u32 v48, 13, v48
    v_cmp_gt_u32 vcc, 64, v48
    s_nop 0
    s_bcnt1_i32_b64 s27, vcc
    s_add_u32 s27, s27, s23
    s_max_i32 s27, s27, 0
    v_mfma_f32_16x16x32_bf16 v[68:71], v[72:75], v[160:163], v[68:71]
    v_and_b32_dpp v76, v29, v16 row_newbcast:14 row_mask:0xf bank_mask:0xf
    v_and_b32_dpp v77, v29, v17 row_newbcast:14 row_mask:0xf bank_mask:0xf
    v_and_b32_dpp v78, v29, v18 row_newbcast:14 row_mask:0xf bank_mask:0xf
    v_and_b32_dpp v79, v29, v19 row_newbcast:14 row_mask:0xf bank_mask:0xf
    s_waitcnt vmcnt(7)
    s_cmp_ge_u32 s27, 36
    s_cbranch_scc1 L_f162
    s_waitcnt vmcnt(5)
L_f162:
    buffer_load_dwordx4 v[208:211], v1, s[36:39], s80 offen offset:2048 nt
    v_mfma_f32_16x16x32_bf16 v[68:71], v[76:79], v[164:167], v[68:71]
    v_and_b32_dpp v72, v29, v16 row_newbcast:3 row_mask:0xf bank_mask:0xf
    v_and_b32_dpp v73, v29, v17 row_newbcast:3 row_mask:0xf bank_mask:0xf
    v_and_b32_dpp v74, v29, v18 row_newbcast:3 row_mask:0xf bank_mask:0xf
    v_and_b32_dpp v75, v29, v19 row_newbcast:3 row_mask:0xf bank_mask:0xf
    s_waitcnt vmcnt(7)
    s_cmp_ge_u32 s27, 39
    s_cbranch_scc1 L_f163
    s_waitcnt vmcnt(5)
L_f163:
    buffer_load_dwordx4 v[212:215], v1, s[36:39], s80 offen offset:3072 nt
    v_mfma_f32_16x16x32_bf16 v[68:71], v[72:75], v[184:187], v[68:71]
    v_and_b32_dpp v76, v29, v16 row_newbcast:7 row_mask:0xf bank_mask:0xf
    v_and_b32_dpp v77, v29, v17 row_newbcast:7 row_mask:0xf bank_mask:0xf
    v_and_b32_dpp v78, v29, v18 row_newbcast:7 row_mask:0xf bank_mask:0xf
    v_and_b32_dpp v79, v29, v19 row_newbcast:7 row_mask:0xf bank_mask:0xf
    s_add_u32 s81, s81, 73728
    buffer_load_dwordx4 a[164:167], v4, s[44:47], s81 offen offset:0
    s_mov_b32 s80, 278528
    s_waitcnt vmcnt(8)
    s_cmp_ge_u32 s27, 43
    s_cbranch_scc1 L_f164
    s_waitcnt vmcnt(5)
L_f164:
    buffer_load_dwordx4 v[216:219], v1, s[36:39], s80 offen offset:0 nt
    v_mfma_f32_16x16x32_bf16 v[68:71], v[76:79], v[188:191], v[68:71]
    v_and_b32_dpp v72, v29, v16 row_newbcast:11 row_mask:0xf bank_mask:0xf
    v_and_b32_dpp v73, v29, v17 row_newbcast:11 row_mask:0xf bank_mask:0xf
    v_and_b32_dpp v74, v29, v18 row_newbcast:11 row_mask:0xf bank_mask:0xf
    v_and_b32_dpp v75, v29, v19 row_newbcast:11 row_mask:0xf bank_mask:0xf
    s_waitcnt vmcnt(8)
    s_cmp_ge_u32 s27, 46
    s_cbranch_scc1 L_f165
    s_waitcnt vmcnt(5)
L_f165:
    buffer_load_dwordx4 v[220:223], v1, s[36:39], s80 offen offset:1024 nt
    v_add_u32 v45, 1, v45
    buffer_store_dword v45, v46, s[68:71], 0 offen
    buffer_load_dword v48, v47, s[68:71], 0 offen nt
    v_mfma_f32_16x16x32_bf16 v[68:71], v[72:75], v[192:195], v[68:71]
    v_and_b32_dpp v76, v29, v16 row_newbcast:15 row_mask:0xf bank_mask:0xf
    v_and_b32_dpp v77, v29, v17 row_newbcast:15 row_mask:0xf bank_mask:0xf
    v_and_b32_dpp v78, v29, v18 row_newbcast:15 row_mask:0xf bank_mask:0xf
    v_and_b32_dpp v79, v29, v19 row_newbcast:15 row_mask:0xf bank_mask:0xf
    s_waitcnt vmcnt(9)
    s_cmp_ge_u32 s27, 49
    s_cbranch_scc1 L_f166
    s_waitcnt vmcnt(7)
L_f166:
    buffer_load_dwordx4 v[224:227], v1, s[36:39], s80 offen offset:2048 nt
    v_mfma_f32_16x16x32_bf16 v[68:71], v[76:79], v[196:199], v[68:71]
    v_and_b32_dpp v72, v30, v16 row_newbcast:0 row_mask:0xf bank_mask:0xf
    v_and_b32_dpp v73, v30, v17 row_newbcast:0 row_mask:0xf bank_mask:0xf
    v_and_b32_dpp v74, v30, v18 row_newbcast:0 row_mask:0xf bank_mask:0xf
    v_and_b32_dpp v75, v30, v19 row_newbcast:0 row_mask:0xf bank_mask:0xf
    s_waitcnt vmcnt(9)
    s_cmp_ge_u32 s27, 52
    s_cbranch_scc1 L_f167
    s_waitcnt vmcnt(7)
L_f167:
    buffer_load_dwordx4 v[228:231], v1, s[36:39], s80 offen offset:3072 nt
    v_mfma_f32_16x16x32_bf16 v[68:71], v[72:75], v[200:203], v[68:71]
    v_and_b32_dpp v76, v30, v16 row_newbcast:4 row_mask:0xf bank_mask:0xf
    v_and_b32_dpp v77, v30, v17 row_newbcast:4 row_mask:0xf bank_mask:0xf
    v_and_b32_dpp v78, v30, v18 row_newbcast:4 row_mask:0xf bank_mask:0xf
    v_and_b32_dpp v79, v30, v19 row_newbcast:4 row_mask:0xf bank_mask:0xf
    buffer_load_dwordx4 a[172:175], v4, s[44:47], s81 offen offset:128
    s_mov_b32 s80, 294912
    s_waitcnt vmcnt(10)
    s_cmp_ge_u32 s27, 56
    s_cbranch_scc1 L_f168
    s_waitcnt vmcnt(8)
L_f168:
    buffer_load_dwordx4 v[232:235], v1, s[36:39], s80 offen offset:0 nt
    v_mfma_f32_16x16x32_bf16 v[68:71], v[76:79], v[204:207], v[68:71]
    v_and_b32_dpp v72, v30, v16 row_newbcast:8 row_mask:0xf bank_mask:0xf
    v_and_b32_dpp v73, v30, v17 row_newbcast:8 row_mask:0xf bank_mask:0xf
    v_and_b32_dpp v74, v30, v18 row_newbcast:8 row_mask:0xf bank_mask:0xf
    v_and_b32_dpp v75, v30, v19 row_newbcast:8 row_mask:0xf bank_mask:0xf
    s_waitcnt vmcnt(10)
    s_cmp_ge_u32 s27, 59
    s_cbranch_scc1 L_f169
    s_waitcnt vmcnt(7)
L_f169:
    buffer_load_dwordx4 v[236:239], v1, s[36:39], s80 offen offset:1024 nt
    v_mfma_f32_16x16x32_bf16 v[68:71], v[72:75], v[208:211], v[68:71]
    v_and_b32_dpp v76, v30, v16 row_newbcast:12 row_mask:0xf bank_mask:0xf
    v_and_b32_dpp v77, v30, v17 row_newbcast:12 row_mask:0xf bank_mask:0xf
    v_and_b32_dpp v78, v30, v18 row_newbcast:12 row_mask:0xf bank_mask:0xf
    v_and_b32_dpp v79, v30, v19 row_newbcast:12 row_mask:0xf bank_mask:0xf
    s_waitcnt vmcnt(10)
    s_cmp_ge_u32 s27, 62
    s_cbranch_scc1 L_f170
    s_waitcnt vmcnt(7)
L_f170:
    buffer_load_dwordx4 v[240:243], v1, s[36:39], s80 offen offset:2048 nt
    v_mfma_f32_16x16x32_bf16 v[68:71], v[76:79], v[212:215], v[68:71]
    v_and_b32_dpp v72, v30, v16 row_newbcast:1 row_mask:0xf bank_mask:0xf
    v_and_b32_dpp v73, v30, v17 row_newbcast:1 row_mask:0xf bank_mask:0xf
    v_and_b32_dpp v74, v30, v18 row_newbcast:1 row_mask:0xf bank_mask:0xf
    v_and_b32_dpp v75, v30, v19 row_newbcast:1 row_mask:0xf bank_mask:0xf
    s_waitcnt vmcnt(9)
    s_cmp_ge_u32 s27, 66
    s_cbranch_scc1 L_f171
    s_waitcnt vmcnt(5)
L_f171:
    buffer_load_dwordx4 v[244:247], v1, s[36:39], s80 offen offset:3072 nt
    v_mfma_f32_16x16x32_bf16 v[68:71], v[72:75], v[216:219], v[68:71]
    v_and_b32_dpp v76, v30, v16 row_newbcast:5 row_mask:0xf bank_mask:0xf
    v_and_b32_dpp v77, v30, v17 row_newbcast:5 row_mask:0xf bank_mask:0xf
    v_and_b32_dpp v78, v30, v18 row_newbcast:5 row_mask:0xf bank_mask:0xf
    v_and_b32_dpp v79, v30, v19 row_newbcast:5 row_mask:0xf bank_mask:0xf
    s_mov_b32 s80, 311296
    s_waitcnt vmcnt(9)
    s_cmp_ge_u32 s27, 69
    s_cbranch_scc1 L_f172
    s_waitcnt vmcnt(5)
L_f172:
    buffer_load_dwordx4 v[248:251], v1, s[36:39], s80 offen offset:0 nt
    v_mfma_f32_16x16x32_bf16 v[68:71], v[76:79], v[220:223], v[68:71]
    v_and_b32_dpp v72, v30, v16 row_newbcast:9 row_mask:0xf bank_mask:0xf
    v_and_b32_dpp v73, v30, v17 row_newbcast:9 row_mask:0xf bank_mask:0xf
    v_and_b32_dpp v74, v30, v18 row_newbcast:9 row_mask:0xf bank_mask:0xf
    v_and_b32_dpp v75, v30, v19 row_newbcast:9 row_mask:0xf bank_mask:0xf
    s_lshl1_add_u32 s81, s3, 4
    s_and_b32 s81, s81, 7
    s_mulk_i32 s81, 4608
    buffer_load_dwordx4 a[176:179], v4, s[44:47], s81 offen offset:0
    s_waitcnt vmcnt(8)
    s_cmp_ge_u32 s27, 72
    s_cbranch_scc1 L_f173
    s_waitcnt vmcnt(5)
L_f173:
    buffer_load_dwordx4 v[252:255], v1, s[36:39], s80 offen offset:1024 nt
    v_subrev_u32 v48, s95, v48
    v_and_b32 v48, 0xfffff0ff, v48
    v_subrev_u32 v48, 14, v48
    v_cmp_gt_u32 vcc, 64, v48
    s_nop 0
    s_bcnt1_i32_b64 s27, vcc
    s_add_u32 s27, s27, s23
    s_max_i32 s27, s27, 0
    v_mfma_f32_16x16x32_bf16 v[68:71], v[72:75], v[224:227], v[68:71]
    v_and_b32_dpp v76, v30, v16 row_newbcast:13 row_mask:0xf bank_mask:0xf
    v_and_b32_dpp v77, v30, v17 row_newbcast:13 row_mask:0xf bank_mask:0xf
    v_and_b32_dpp v78, v30, v18 row_newbcast:13 row_mask:0xf bank_mask:0xf
    v_and_b32_dpp v79, v30, v19 row_newbcast:13 row_mask:0xf bank_mask:0xf
    s_waitcnt vmcnt(8)
    s_cmp_ge_u32 s27, 36
    s_cbranch_scc1 L_f174
    s_waitcnt vmcnt(5)
L_f174:
    buffer_load_dwordx4 v[168:171], v1, s[36:39], s80 offen offset:2048 nt
    v_mfma_f32_16x16x32_bf16 v[68:71], v[76:79], v[228:231], v[68:71]
    v_and_b32_dpp v72, v30, v16 row_newbcast:2 row_mask:0xf bank_mask:0xf
    v_and_b32_dpp v73, v30, v17 row_newbcast:2 row_mask:0xf bank_mask:0xf
    v_and_b32_dpp v74, v30, v18 row_newbcast:2 row_mask:0xf bank_mask:0xf
    v_and_b32_dpp v75, v30, v19 row_newbcast:2 row_mask:0xf bank_mask:0xf
    s_waitcnt vmcnt(7)
    s_cmp_ge_u32 s27, 39
    s_cbranch_scc1 L_f175
    s_waitcnt vmcnt(5)
L_f175:
    buffer_load_dwordx4 v[172:175], v1, s[36:39], s80 offen offset:3072 nt
    v_mfma_f32_16x16x32_bf16 v[68:71], v[72:75], v[232:235], v[68:71]
    v_and_b32_dpp v76, v30, v16 row_newbcast:6 row_mask:0xf bank_mask:0xf
    v_and_b32_dpp v77, v30, v17 row_newbcast:6 row_mask:0xf bank_mask:0xf
    v_and_b32_dpp v78, v30, v18 row_newbcast:6 row_mask:0xf bank_mask:0xf
    v_and_b32_dpp v79, v30, v19 row_newbcast:6 row_mask:0xf bank_mask:0xf
    s_mov_b32 s80, 393216
    s_waitcnt vmcnt(7)
    s_cmp_ge_u32 s27, 43
    s_cbranch_scc1 L_f176
    s_waitcnt vmcnt(5)
L_f176:
    buffer_load_dwordx4 v[176:179], v1, s[36:39], s80 offen offset:0 nt
    v_mfma_f32_16x16x32_bf16 v[68:71], v[76:79], v[236:239], v[68:71]
    v_and_b32_dpp v72, v30, v16 row_newbcast:10 row_mask:0xf bank_mask:0xf
    v_and_b32_dpp v73, v30, v17 row_newbcast:10 row_mask:0xf bank_mask:0xf
    v_and_b32_dpp v74, v30, v18 row_newbcast:10 row_mask:0xf bank_mask:0xf
    v_and_b32_dpp v75, v30, v19 row_newbcast:10 row_mask:0xf bank_mask:0xf
    buffer_load_dwordx4 a[184:187], v4, s[44:47], s81 offen offset:128
    s_waitcnt vmcnt(8)
    s_cmp_ge_u32 s27, 46
    s_cbranch_scc1 L_f177
    s_waitcnt vmcnt(6)
L_f177:
    buffer_load_dwordx4 v[180:183], v1, s[36:39], s80 offen offset:1024 nt
    v_add_u32 v45, 1, v45
    buffer_store_dword v45, v46, s[68:71], 0 offen
    buffer_load_dword v48, v47, s[68:71], 0 offen nt
    v_mfma_f32_16x16x32_bf16 v[68:71], v[72:75], v[240:243], v[68:71]
    v_and_b32_dpp v76, v30, v16 row_newbcast:14 row_mask:0xf bank_mask:0xf
    v_and_b32_dpp v77, v30, v17 row_newbcast:14 row_mask:0xf bank_mask:0xf
    v_and_b32_dpp v78, v30, v18 row_newbcast:14 row_mask:0xf bank_mask:0xf
    v_and_b32_dpp v79, v30, v19 row_newbcast:14 row_mask:0xf bank_mask:0xf
    s_waitcnt vmcnt(10)
    s_cmp_ge_u32 s27, 49
    s_cbranch_scc1 L_f178
    s_waitcnt vmcnt(7)
L_f178:
    buffer_load_dwordx4 v[112:115], v1, s[36:39], s80 offen offset:2048 nt
    v_mfma_f32_16x16x32_bf16 v[68:71], v[76:79], v[244:247], v[68:71]
    v_and_b32_dpp v72, v30, v16 row_newbcast:3 row_mask:0xf bank_mask:0xf
    v_and_b32_dpp v73, v30, v17 row_newbcast:3 row_mask:0xf bank_mask:0xf
    v_and_b32_dpp v74, v30, v18 row_newbcast:3 row_mask:0xf bank_mask:0xf
    v_and_b32_dpp v75, v30, v19 row_newbcast:3 row_mask:0xf bank_mask:0xf
    s_waitcnt vmcnt(10)
    s_cmp_ge_u32 s27, 52
    s_cbranch_scc1 L_f179
    s_waitcnt vmcnt(7)
L_f179:
    buffer_load_dwordx4 v[116:119], v1, s[36:39], s80 offen offset:3072 nt
    v_mfma_f32_16x16x32_bf16 v[68:71], v[72:75], v[248:251], v[68:71]
    v_and_b32_dpp v76, v30, v16 row_newbcast:7 row_mask:0xf bank_mask:0xf
    v_and_b32_dpp v77, v30, v17 row_newbcast:7 row_mask:0xf bank_mask:0xf
    v_and_b32_dpp v78, v30, v18 row_newbcast:7 row_mask:0xf bank_mask:0xf
    v_and_b32_dpp v79, v30, v19 row_newbcast:7 row_mask:0xf bank_mask:0xf
    s_mov_b32 s80, 409600
    s_waitcnt vmcnt(9)
    s_cmp_ge_u32 s27, 56
    s_cbranch_scc1 L_f180
    s_waitcnt vmcnt(7)
L_f180:
    buffer_load_dwordx4 v[120:123], v1, s[36:39], s80 offen offset:0 nt
    v_mfma_f32_16x16x32_bf16 v[68:71], v[76:79], v[252:255], v[68:71]
    v_and_b32_dpp v72, v30, v16 row_newbcast:11 row_mask:0xf bank_mask:0xf
    v_and_b32_dpp v73, v30, v17 row_newbcast:11 row_mask:0xf bank_mask:0xf
    v_and_b32_dpp v74, v30, v18 row_newbcast:11 row_mask:0xf bank_mask:0xf
    v_and_b32_dpp v75, v30, v19 row_newbcast:11 row_mask:0xf bank_mask:0xf
    s_waitcnt vmcnt(9)
    s_cmp_ge_u32 s27, 59
    s_cbranch_scc1 L_f181
    s_waitcnt vmcnt(7)
L_f181:
    buffer_load_dwordx4 v[124:127], v1, s[36:39], s80 offen offset:1024 nt
    v_mfma_f32_16x16x32_bf16 v[68:71], v[72:75], v[168:171], v[68:71]
    v_and_b32_dpp v76, v30, v16 row_newbcast:15 row_mask:0xf bank_mask:0xf
    v_and_b32_dpp v77, v30, v17 row_newbcast:15 row_mask:0xf bank_mask:0xf
    v_and_b32_dpp v78, v30, v18 row_newbcast:15 row_mask:0xf bank_mask:0xf
    v_and_b32_dpp v79, v30, v19 row_newbcast:15 row_mask:0xf bank_mask:0xf
    s_add_u32 s81, s81, 73728
    buffer_load_dwordx4 a[180:183], v4, s[44:47], s81 offen offset:0
    s_waitcnt vmcnt(10)
    s_cmp_ge_u32 s27, 62
    s_cbranch_scc1 L_f182
    s_waitcnt vmcnt(7)
L_f182:
    buffer_load_dwordx4 v[128:131], v1, s[36:39], s80 offen offset:2048 nt
    v_mfma_f32_16x16x32_bf16 v[68:71], v[76:79], v[172:175], v[68:71]
    v_and_b32_dpp v72, v31, v16 row_newbcast:0 row_mask:0xf bank_mask:0xf
    v_and_b32_dpp v73, v31, v17 row_newbcast:0 row_mask:0xf bank_mask:0xf
    v_and_b32_dpp v74, v31, v18 row_newbcast:0 row_mask:0xf bank_mask:0xf
    v_and_b32_dpp v75, v31, v19 row_newbcast:0 row_mask:0xf bank_mask:0xf
    s_waitcnt vmcnt(10)
    s_cmp_ge_u32 s27, 66
    s_cbranch_scc1 L_f183
    s_waitcnt vmcnt(5)
L_f183:
    buffer_load_dwordx4 v[132:135], v1, s[36:39], s80 offen offset:3072 nt
    v_mfma_f32_16x16x32_bf16 v[68:71], v[72:75], v[176:179], v[68:71]
    v_and_b32_dpp v76, v31, v16 row_newbcast:4 row_mask:0xf bank_mask:0xf
    v_and_b32_dpp v77, v31, v17 row_newbcast:4 row_mask:0xf bank_mask:0xf
    v_and_b32_dpp v78, v31, v18 row_newbcast:4 row_mask:0xf bank_mask:0xf
    v_and_b32_dpp v79, v31, v19 row_newbcast:4 row_mask:0xf bank_mask:0xf
    s_mov_b32 s80, 425984
    s_waitcnt vmcnt(9)
    s_cmp_ge_u32 s27, 69
    s_cbranch_scc1 L_f184
    s_waitcnt vmcnt(5)
L_f184:
    buffer_load_dwordx4 v[136:139], v1, s[36:39], s80 offen offset:0 nt
    v_mfma_f32_16x16x32_bf16 v[68:71], v[76:79], v[180:183], v[68:71]
    v_and_b32_dpp v72, v31, v16 row_newbcast:8 row_mask:0xf bank_mask:0xf
    v_and_b32_dpp v73, v31, v17 row_newbcast:8 row_mask:0xf bank_mask:0xf
    v_and_b32_dpp v74, v31, v18 row_newbcast:8 row_mask:0xf bank_mask:0xf
    v_and_b32_dpp v75, v31, v19 row_newbcast:8 row_mask:0xf bank_mask:0xf
    s_waitcnt vmcnt(7)
    s_cmp_ge_u32 s27, 72
    s_cbranch_scc1 L_f185
    s_waitcnt vmcnt(5)
L_f185:
    buffer_load_dwordx4 v[140:143], v1, s[36:39], s80 offen offset:1024 nt
    v_subrev_u32 v48, s95, v48
    v_and_b32 v48, 0xfffff0ff, v48
    v_subrev_u32 v48, 15, v48
    v_cmp_gt_u32 vcc, 64, v48
    s_nop 0
    s_bcnt1_i32_b64 s27, vcc
    s_add_u32 s27, s27, s23
    s_max_i32 s27, s27, 0
    v_mfma_f32_16x16x32_bf16 v[68:71], v[72:75], v[112:115], v[68:71]
    v_and_b32_dpp v76, v31, v16 row_newbcast:12 row_mask:0xf bank_mask:0xf
    v_and_b32_dpp v77, v31, v17 row_newbcast:12 row_mask:0xf bank_mask:0xf
    v_and_b32_dpp v78, v31, v18 row_newbcast:12 row_mask:0xf bank_mask:0xf
    v_and_b32_dpp v79, v31, v19 row_newbcast:12 row_mask:0xf bank_mask:0xf
    buffer_load_dwordx4 a[188:191], v4, s[44:47], s81 offen offset:128
    s_waitcnt vmcnt(8)
    s_cmp_ge_u32 s27, 36
    s_cbranch_scc1 L_f186
    s_waitcnt vmcnt(6)
L_f186:
    buffer_load_dwordx4 v[144:147], v1, s[36:39], s80 offen offset:2048 nt
    v_mfma_f32_16x16x32_bf16 v[68:71], v[76:79], v[116:119], v[68:71]
    v_and_b32_dpp v72, v31, v16 row_newbcast:1 row_mask:0xf bank_mask:0xf
    v_and_b32_dpp v73, v31, v17 row_newbcast:1 row_mask:0xf bank_mask:0xf
    v_and_b32_dpp v74, v31, v18 row_newbcast:1 row_mask:0xf bank_mask:0xf
    v_and_b32_dpp v75, v31, v19 row_newbcast:1 row_mask:0xf bank_mask:0xf
    s_waitcnt vmcnt(8)
    s_cmp_ge_u32 s27, 39
    s_cbranch_scc1 L_f187
    s_waitcnt vmcnt(5)
L_f187:
    buffer_load_dwordx4 v[148:151], v1, s[36:39], s80 offen offset:3072 nt
    v_mfma_f32_16x16x32_bf16 v[68:71], v[72:75], v[120:123], v[68:71]
    v_and_b32_dpp v76, v31, v16 row_newbcast:5 row_mask:0xf bank_mask:0xf
    v_and_b32_dpp v77, v31, v17 row_newbcast:5 row_mask:0xf bank_mask:0xf
    v_and_b32_dpp v78, v31, v18 row_newbcast:5 row_mask:0xf bank_mask:0xf
    v_and_b32_dpp v79, v31, v19 row_newbcast:5 row_mask:0xf bank_mask:0xf
    s_mov_b32 s80, 442368
    s_waitcnt vmcnt(8)
    s_cmp_ge_u32 s27, 43
    s_cbranch_scc1 L_f188
    s_waitcnt vmcnt(5)
L_f188:
    buffer_load_dwordx4 v[152:155], v1, s[36:39], s80 offen offset:0 nt
    v_mfma_f32_16x16x32_bf16 v[68:71], v[76:79], v[124:127], v[68:71]
    v_and_b32_dpp v72, v31, v16 row_newbcast:9 row_mask:0xf bank_mask:0xf
    v_and_b32_dpp v73, v31, v17 row_newbcast:9 row_mask:0xf bank_mask:0xf
    v_and_b32_dpp v74, v31, v18 row_newbcast:9 row_mask:0xf bank_mask:0xf
    v_and_b32_dpp v75, v31, v19 row_newbcast:9 row_mask:0xf bank_mask:0xf
    s_waitcnt vmcnt(7)
    s_cmp_ge_u32 s27, 46
    s_cbranch_scc1 L_f189
    s_waitcnt vmcnt(5)
L_f189:
    buffer_load_dwordx4 v[156:159], v1, s[36:39], s80 offen offset:1024 nt
    v_add_u32 v45, 1, v45
    buffer_store_dword v45, v46, s[68:71], 0 offen
    buffer_load_dword v48, v47, s[68:71], 0 offen nt
    v_mfma_f32_16x16x32_bf16 v[68:71], v[72:75], v[128:131], v[68:71]
    v_and_b32_dpp v76, v31, v16 row_newbcast:13 row_mask:0xf bank_mask:0xf
    v_and_b32_dpp v77, v31, v17 row_newbcast:13 row_mask:0xf bank_mask:0xf
    v_and_b32_dpp v78, v31, v18 row_newbcast:13 row_mask:0xf bank_mask:0xf
    v_and_b32_dpp v79, v31, v19 row_newbcast:13 row_mask:0xf bank_mask:0xf
    s_waitcnt vmcnt(9)
    s_cmp_ge_u32 s27, 49
    s_cbranch_scc1 L_f190
    s_waitcnt vmcnt(7)
L_f190:
    buffer_load_dwordx4 v[160:163], v1, s[36:39], s80 offen offset:2048 nt
    v_mfma_f32_16x16x32_bf16 v[68:71], v[76:79], v[132:135], v[68:71]
    v_and_b32_dpp v72, v31, v16 row_newbcast:2 row_mask:0xf bank_mask:0xf
    v_and_b32_dpp v73, v31, v17 row_newbcast:2 row_mask:0xf bank_mask:0xf
    v_and_b32_dpp v74, v31, v18 row_newbcast:2 row_mask:0xf bank_mask:0xf
    v_and_b32_dpp v75, v31, v19 row_newbcast:2 row_mask:0xf bank_mask:0xf
    s_lshl1_add_u32 s81, s3, 5
    s_and_b32 s81, s81, 7
    s_mulk_i32 s81, 4608
    buffer_load_dwordx4 a[192:195], v4, s[44:47], s81 offen offset:0
    s_waitcnt vmcnt(10)
    s_cmp_ge_u32 s27, 52
    s_cbranch_scc1 L_f191
    s_waitcnt vmcnt(7)
L_f191:
    buffer_load_dwordx4 v[164:167], v1, s[36:39], s80 offen offset:3072 nt
    v_mfma_f32_16x16x32_bf16 v[68:71], v[72:75], v[136:139], v[68:71]
    v_and_b32_dpp v76, v31, v16 row_newbcast:6 row_mask:0xf bank_mask:0xf
    v_and_b32_dpp v77, v31, v17 row_newbcast:6 row_mask:0xf bank_mask:0xf
    v_and_b32_dpp v78, v31, v18 row_newbcast:6 row_mask:0xf bank_mask:0xf
    v_and_b32_dpp v79, v31, v19 row_newbcast:6 row_mask:0xf bank_mask:0xf
    s_mov_b32 s80, 524288
    s_waitcnt vmcnt(10)
    s_cmp_ge_u32 s27, 56
    s_cbranch_scc1 L_f192
    s_waitcnt vmcnt(7)
L_f192:
    buffer_load_dwordx4 v[184:187], v1, s[36:39], s80 offen offset:0 nt
    v_mfma_f32_16x16x32_bf16 v[68:71], v[76:79], v[140:143], v[68:71]
    v_and_b32_dpp v72, v31, v16 row_newbcast:10 row_mask:0xf bank_mask:0xf
    v_and_b32_dpp v73, v31, v17 row_newbcast:10 row_mask:0xf bank_mask:0xf
    v_and_b32_dpp v74, v31, v18 row_newbcast:10 row_mask:0xf bank_mask:0xf
    v_and_b32_dpp v75, v31, v19 row_newbcast:10 row_mask:0xf bank_mask:0xf
    s_waitcnt vmcnt(9)
    s_cmp_ge_u32 s27, 59
    s_cbranch_scc1 L_f193
    s_waitcnt vmcnt(7)
L_f193:
    buffer_load_dwordx4 v[188:191], v1, s[36:39], s80 offen offset:1024 nt
    v_mfma_f32_16x16x32_bf16 v[68:71], v[72:75], v[144:147], v[68:71]
    v_and_b32_dpp v76, v31, v16 row_newbcast:14 row_mask:0xf bank_mask:0xf
    v_and_b32_dpp v77, v31, v17 row_newbcast:14 row_mask:0xf bank_mask:0xf
    v_and_b32_dpp v78, v31, v18 row_newbcast:14 row_mask:0xf bank_mask:0xf
    v_and_b32_dpp v79, v31, v19 row_newbcast:14 row_mask:0xf bank_mask:0xf
    s_waitcnt vmcnt(9)
    s_cmp_ge_u32 s27, 62
    s_cbranch_scc1 L_f194
    s_waitcnt vmcnt(7)
L_f194:
    buffer_load_dwordx4 v[192:195], v1, s[36:39], s80 offen offset:2048 nt
    v_mfma_f32_16x16x32_bf16 v[68:71], v[76:79], v[148:151], v[68:71]
    v_and_b32_dpp v72, v31, v16 row_newbcast:3 row_mask:0xf bank_mask:0xf
    v_and_b32_dpp v73, v31, v17 row_newbcast:3 row_mask:0xf bank_mask:0xf
    v_and_b32_dpp v74, v31, v18 row_newbcast:3 row_mask:0xf bank_mask:0xf
    v_and_b32_dpp v75, v31, v19 row_newbcast:3 row_mask:0xf bank_mask:0xf
    buffer_load_dwordx4 a[200:203], v4, s[44:47], s81 offen offset:128
    s_waitcnt vmcnt(10)
    s_cmp_ge_u32 s27, 66
    s_cbranch_scc1 L_f195
    s_waitcnt vmcnt(6)
L_f195:
    buffer_load_dwordx4 v[196:199], v1, s[36:39], s80 offen offset:3072 nt
    v_mfma_f32_16x16x32_bf16 v[68:71], v[72:75], v[152:155], v[68:71]
    v_and_b32_dpp v76, v31, v16 row_newbcast:7 row_mask:0xf bank_mask:0xf
    v_and_b32_dpp v77, v31, v17 row_newbcast:7 row_mask:0xf bank_mask:0xf
    v_and_b32_dpp v78, v31, v18 row_newbcast:7 row_mask:0xf bank_mask:0xf
    v_and_b32_dpp v79, v31, v19 row_newbcast:7 row_mask:0xf bank_mask:0xf
    s_mov_b32 s80, 540672
    s_waitcnt vmcnt(10)
    s_cmp_ge_u32 s27, 69
    s_cbranch_scc1 L_f196
    s_waitcnt vmcnt(5)
L_f196:
    buffer_load_dwordx4 v[200:203], v1, s[36:39], s80 offen offset:0 nt
    v_mfma_f32_16x16x32_bf16 v[68:71], v[76:79], v[156:159], v[68:71]
    v_and_b32_dpp v72, v31, v16 row_newbcast:11 row_mask:0xf bank_mask:0xf
    v_and_b32_dpp v73, v31, v17 row_newbcast:11 row_mask:0xf bank_mask:0xf
    v_and_b32_dpp v74, v31, v18 row_newbcast:11 row_mask:0xf bank_mask:0xf
    v_and_b32_dpp v75, v31, v19 row_newbcast:11 row_mask:0xf bank_mask:0xf
    s_waitcnt vmcnt(8)
    s_cmp_ge_u32 s27, 72
    s_cbranch_scc1 L_f197
    s_waitcnt vmcnt(5)
L_f197:
    buffer_load_dwordx4 v[204:207], v1, s[36:39], s80 offen offset:1024 nt
    v_subrev_u32 v48, s95, v48
    v_and_b32 v48, 0xfffff0ff, v48
    v_subrev_u32 v48, 16, v48
    v_cmp_gt_u32 vcc, 64, v48
    s_nop 0
    s_bcnt1_i32_b64 s27, vcc
    s_add_u32 s27, s27, s23
    s_max_i32 s27, s27, 0
    v_mfma_f32_16x16x32_bf16 v[68:71], v[72:75], v[160:163], v[68:71]
    v_and_b32_dpp v76, v31, v16 row_newbcast:15 row_mask:0xf bank_mask:0xf
    v_and_b32_dpp v77, v31, v17 row_newbcast:15 row_mask:0xf bank_mask:0xf
    v_and_b32_dpp v78, v31, v18 row_newbcast:15 row_mask:0xf bank_mask:0xf
    v_and_b32_dpp v79, v31, v19 row_newbcast:15 row_mask:0xf bank_mask:0xf
    s_waitcnt vmcnt(7)
    s_cmp_ge_u32 s27, 36
    s_cbranch_scc1 L_f198
    s_waitcnt vmcnt(5)
L_f198:
    buffer_load_dwordx4 v[208:211], v1, s[36:39], s80 offen offset:2048 nt
    v_mfma_f32_16x16x32_bf16 v[68:71], v[76:79], v[164:167], v[68:71]
    v_and_b32_dpp v72, v32, v16 row_newbcast:0 row_mask:0xf bank_mask:0xf
    v_and_b32_dpp v73, v32, v17 row_newbcast:0 row_mask:0xf bank_mask:0xf
    v_and_b32_dpp v74, v32, v18 row_newbcast:0 row_mask:0xf bank_mask:0xf
    v_and_b32_dpp v75, v32, v19 row_newbcast:0 row_mask:0xf bank_mask:0xf
    s_waitcnt vmcnt(7)
    s_cmp_ge_u32 s27, 39
    s_cbranch_scc1 L_f199
    s_waitcnt vmcnt(5)
L_f199:
    buffer_load_dwordx4 v[212:215], v1, s[36:39], s80 offen offset:3072 nt
    v_mfma_f32_16x16x32_bf16 v[68:71], v[72:75], v[184:187], v[68:71]
    v_and_b32_dpp v76, v32, v16 row_newbcast:4 row_mask:0xf bank_mask:0xf
    v_and_b32_dpp v77, v32, v17 row_newbcast:4 row_mask:0xf bank_mask:0xf
    v_and_b32_dpp v78, v32, v18 row_newbcast:4 row_mask:0xf bank_mask:0xf
    v_and_b32_dpp v79, v32, v19 row_newbcast:4 row_mask:0xf bank_mask:0xf
    s_add_u32 s81, s81, 73728
    buffer_load_dwordx4 a[196:199], v4, s[44:47], s81 offen offset:0
    s_mov_b32 s80, 557056
    s_waitcnt vmcnt(8)
    s_cmp_ge_u32 s27, 43
    s_cbranch_scc1 L_f200
    s_waitcnt vmcnt(5)
L_f200:
    buffer_load_dwordx4 v[216:219], v1, s[36:39], s80 offen offset:0 nt
    v_mfma_f32_16x16x32_bf16 v[68:71], v[76:79], v[188:191], v[68:71]
    v_and_b32_dpp v72, v32, v16 row_newbcast:8 row_mask:0xf bank_mask:0xf
    v_and_b32_dpp v73, v32, v17 row_newbcast:8 row_mask:0xf bank_mask:0xf
    v_and_b32_dpp v74, v32, v18 row_newbcast:8 row_mask:0xf bank_mask:0xf
    v_and_b32_dpp v75, v32, v19 row_newbcast:8 row_mask:0xf bank_mask:0xf
    s_waitcnt vmcnt(8)
    s_cmp_ge_u32 s27, 46
    s_cbranch_scc1 L_f201
    s_waitcnt vmcnt(5)
L_f201:
    buffer_load_dwordx4 v[220:223], v1, s[36:39], s80 offen offset:1024 nt
    v_add_u32 v45, 1, v45
    buffer_store_dword v45, v46, s[68:71], 0 offen
    buffer_load_dword v48, v47, s[68:71], 0 offen nt
    v_mfma_f32_16x16x32_bf16 v[68:71], v[72:75], v[192:195], v[68:71]
    v_and_b32_dpp v76, v32, v16 row_newbcast:12 row_mask:0xf bank_mask:0xf
    v_and_b32_dpp v77, v32, v17 row_newbcast:12 row_mask:0xf bank_mask:0xf
    v_and_b32_dpp v78, v32, v18 row_newbcast:12 row_mask:0xf bank_mask:0xf
    v_and_b32_dpp v79, v32, v19 row_newbcast:12 row_mask:0xf bank_mask:0xf
    s_waitcnt vmcnt(9)
    s_cmp_ge_u32 s27, 49
    s_cbranch_scc1 L_f202
    s_waitcnt vmcnt(7)
L_f202:
    buffer_load_dwordx4 v[224:227], v1, s[36:39], s80 offen offset:2048 nt
    v_mfma_f32_16x16x32_bf16 v[68:71], v[76:79], v[196:199], v[68:71]
    v_and_b32_dpp v72, v32, v16 row_newbcast:1 row_mask:0xf bank_mask:0xf
    v_and_b32_dpp v73, v32, v17 row_newbcast:1 row_mask:0xf bank_mask:0xf
    v_and_b32_dpp v74, v32, v18 row_newbcast:1 row_mask:0xf bank_mask:0xf
    v_and_b32_dpp v75, v32, v19 row_newbcast:1 row_mask:0xf bank_mask:0xf
    s_waitcnt vmcnt(9)
    s_cmp_ge_u32 s27, 52
    s_cbranch_scc1 L_f203
    s_waitcnt vmcnt(7)
L_f203:
    buffer_load_dwordx4 v[228:231], v1, s[36:39], s80 offen offset:3072 nt
    v_mfma_f32_16x16x32_bf16 v[68:71], v[72:75], v[200:203], v[68:71]
    v_and_b32_dpp v76, v32, v16 row_newbcast:5 row_mask:0xf bank_mask:0xf
    v_and_b32_dpp v77, v32, v17 row_newbcast:5 row_mask:0xf bank_mask:0xf
    v_and_b32_dpp v78, v32, v18 row_newbcast:5 row_mask:0xf bank_mask:0xf
    v_and_b32_dpp v79, v32, v19 row_newbcast:5 row_mask:0xf bank_mask:0xf
    buffer_load_dwordx4 a[204:207], v4, s[44:47], s81 offen offset:128
    s_mov_b32 s80, 573440
    s_waitcnt vmcnt(10)
    s_cmp_ge_u32 s27, 56
    s_cbranch_scc1 L_f204
    s_waitcnt vmcnt(8)
L_f204:
    buffer_load_dwordx4 v[232:235], v1, s[36:39], s80 offen offset:0 nt
    v_mfma_f32_16x16x32_bf16 v[68:71], v[76:79], v[204:207], v[68:71]
    v_and_b32_dpp v72, v32, v16 row_newbcast:9 row_mask:0xf bank_mask:0xf
    v_and_b32_dpp v73, v32, v17 row_newbcast:9 row_mask:0xf bank_mask:0xf
    v_and_b32_dpp v74, v32, v18 row_newbcast:9 row_mask:0xf bank_mask:0xf
    v_and_b32_dpp v75, v32, v19 row_newbcast:9 row_mask:0xf bank_mask:0xf
    s_waitcnt vmcnt(10)
    s_cmp_ge_u32 s27, 59
    s_cbranch_scc1 L_f205
    s_waitcnt vmcnt(7)
L_f205:
    buffer_load_dwordx4 v[236:239], v1, s[36:39], s80 offen offset:1024 nt
    v_mfma_f32_16x16x32_bf16 v[68:71], v[72:75], v[208:211], v[68:71]
    v_and_b32_dpp v76, v32, v16 row_newbcast:13 row_mask:0xf bank_mask:0xf
    v_and_b32_dpp v77, v32, v17 row_newbcast:13 row_mask:0xf bank_mask:0xf
    v_and_b32_dpp v78, v32, v18 row_newbcast:13 row_mask:0xf bank_mask:0xf
    v_and_b32_dpp v79, v32, v19 row_newbcast:13 row_mask:0xf bank_mask:0xf
    s_waitcnt vmcnt(10)
    s_cmp_ge_u32 s27, 62
    s_cbranch_scc1 L_f206
    s_waitcnt vmcnt(7)
L_f206:
    buffer_load_dwordx4 v[240:243], v1, s[36:39], s80 offen offset:2048 nt
    v_mfma_f32_16x16x32_bf16 v[68:71], v[76:79], v[212:215], v[68:71]
    v_and_b32_dpp v72, v32, v16 row_newbcast:2 row_mask:0xf bank_mask:0xf
    v_and_b32_dpp v73, v32, v17 row_newbcast:2 row_mask:0xf bank_mask:0xf
    v_and_b32_dpp v74, v32, v18 row_newbcast:2 row_mask:0xf bank_mask:0xf
    v_and_b32_dpp v75, v32, v19 row_newbcast:2 row_mask:0xf bank_mask:0xf
    s_waitcnt vmcnt(9)
    s_cmp_ge_u32 s27, 66
    s_cbranch_scc1 L_f207
    s_waitcnt vmcnt(5)
L_f207:
    buffer_load_dwordx4 v[244:247], v1, s[36:39], s80 offen offset:3072 nt
    v_mfma_f32_16x16x32_bf16 v[68:71], v[72:75], v[216:219], v[68:71]
    v_and_b32_dpp v76, v32, v16 row_newbcast:6 row_mask:0xf bank_mask:0xf
    v_and_b32_dpp v77, v32, v17 row_newbcast:6 row_mask:0xf bank_mask:0xf
    v_and_b32_dpp v78, v32, v18 row_newbcast:6 row_mask:0xf bank_mask:0xf
    v_and_b32_dpp v79, v32, v19 row_newbcast:6 row_mask:0xf bank_mask:0xf
    s_mov_b32 s80, 655360
    s_waitcnt vmcnt(9)
    s_cmp_ge_u32 s27, 69
    s_cbranch_scc1 L_f208
    s_waitcnt vmcnt(5)
L_f208:
    buffer_load_dwordx4 v[248:251], v1, s[36:39], s80 offen offset:0 nt
    v_mfma_f32_16x16x32_bf16 v[68:71], v[76:79], v[220:223], v[68:71]
    v_and_b32_dpp v72, v32, v16 row_newbcast:10 row_mask:0xf bank_mask:0xf
    v_and_b32_dpp v73, v32, v17 row_newbcast:10 row_mask:0xf bank_mask:0xf
    v_and_b32_dpp v74, v32, v18 row_newbcast:10 row_mask:0xf bank_mask:0xf
    v_and_b32_dpp v75, v32, v19 row_newbcast:10 row_mask:0xf bank_mask:0xf
    s_lshl1_add_u32 s81, s3, 6
    s_and_b32 s81, s81, 7
    s_mulk_i32 s81, 4608
    buffer_load_dwordx4 a[208:211], v4, s[44:47], s81 offen offset:0
    s_waitcnt vmcnt(8)
    s_cmp_ge_u32 s27, 72
    s_cbranch_scc1 L_f209
    s_waitcnt vmcnt(5)
L_f209:
    buffer_load_dwordx4 v[252:255], v1, s[36:39], s80 offen offset:1024 nt
    v_subrev_u32 v48, s95, v48
    v_and_b32 v48, 0xfffff0ff, v48
    v_subrev_u32 v48, 17, v48
    v_cmp_gt_u32 vcc, 64, v48
    s_nop 0
    s_bcnt1_i32_b64 s27, vcc
    s_add_u32 s27, s27, s23
    s_max_i32 s27, s27, 0
    v_mfma_f32_16x16x32_bf16 v[68:71], v[72:75], v[224:227], v[68:71]
    v_and_b32_dpp v76, v32, v16 row_newbcast:14 row_mask:0xf bank_mask:0xf
    v_and_b32_dpp v77, v32, v17 row_newbcast:14 row_mask:0xf bank_mask:0xf
    v_and_b32_dpp v78, v32, v18 row_newbcast:14 row_mask:0xf bank_mask:0xf
    v_and_b32_dpp v79, v32, v19 row_newbcast:14 row_mask:0xf bank_mask:0xf
    s_waitcnt vmcnt(8)
    s_cmp_ge_u32 s27, 36
    s_cbranch_scc1 L_f210
    s_waitcnt vmcnt(5)
L_f210:
    buffer_load_dwordx4 v[168:171], v1, s[36:39], s80 offen offset:2048 nt
    v_mfma_f32_16x16x32_bf16 v[68:71], v[76:79], v[228:231], v[68:71]
    v_and_b32_dpp v72, v32, v16 row_newbcast:3 row_mask:0xf bank_mask:0xf
    v_and_b32_dpp v73, v32, v17 row_newbcast:3 row_mask:0xf bank_mask:0xf
    v_and_b32_dpp v74, v32, v18 row_newbcast:3 row_mask:0xf bank_mask:0xf
    v_and_b32_dpp v75, v32, v19 row_newbcast:3 row_mask:0xf bank_mask:0xf
    s_waitcnt vmcnt(7)
    s_cmp_ge_u32 s27, 39
    s_cbranch_scc1 L_f211
    s_waitcnt vmcnt(5)
L_f211:
    buffer_load_dwordx4 v[172:175], v1, s[36:39], s80 offen offset:3072 nt
    v_mfma_f32_16x16x32_bf16 v[68:71], v[72:75], v[232:235], v[68:71]
    v_and_b32_dpp v76, v32, v16 row_newbcast:7 row_mask:0xf bank_mask:0xf
    v_and_b32_dpp v77, v32, v17 row_newbcast:7 row_mask:0xf bank_mask:0xf
    v_and_b32_dpp v78, v32, v18 row_newbcast:7 row_mask:0xf bank_mask:0xf
    v_and_b32_dpp v79, v32, v19 row_newbcast:7 row_mask:0xf bank_mask:0xf
    s_mov_b32 s80, 671744
    s_waitcnt vmcnt(7)
    s_cmp_ge_u32 s27, 43
    s_cbranch_scc1 L_f212
    s_waitcnt vmcnt(5)
L_f212:
    buffer_load_dwordx4 v[176:179], v1, s[36:39], s80 offen offset:0 nt
    v_mfma_f32_16x16x32_bf16 v[68:71], v[76:79], v[236:239], v[68:71]
    v_and_b32_dpp v72, v32, v16 row_newbcast:11 row_mask:0xf bank_mask:0xf
    v_and_b32_dpp v73, v32, v17 row_newbcast:11 row_mask:0xf bank_mask:0xf
    v_and_b32_dpp v74, v32, v18 row_newbcast:11 row_mask:0xf bank_mask:0xf
    v_and_b32_dpp v75, v32, v19 row_newbcast:11 row_mask:0xf bank_mask:0xf
    buffer_load_dwordx4 a[216:219], v4, s[44:47], s81 offen offset:128
    s_waitcnt vmcnt(8)
    s_cmp_ge_u32 s27, 46
    s_cbranch_scc1 L_f213
    s_waitcnt vmcnt(6)
L_f213:
    buffer_load_dwordx4 v[180:183], v1, s[36:39], s80 offen offset:1024 nt
    v_add_u32 v45, 1, v45
    buffer_store_dword v45, v46, s[68:71], 0 offen
    buffer_load_dword v48, v47, s[68:71], 0 offen nt
    v_mfma_f32_16x16x32_bf16 v[68:71], v[72:75], v[240:243], v[68:71]
    v_and_b32_dpp v76, v32, v16 row_newbcast:15 row_mask:0xf bank_mask:0xf
    v_and_b32_dpp v77, v32, v17 row_newbcast:15 row_mask:0xf bank_mask:0xf
    v_and_b32_dpp v78, v32, v18 row_newbcast:15 row_mask:0xf bank_mask:0xf
    v_and_b32_dpp v79, v32, v19 row_newbcast:15 row_mask:0xf bank_mask:0xf
    s_waitcnt vmcnt(10)
    s_cmp_ge_u32 s27, 49
    s_cbranch_scc1 L_f214
    s_waitcnt vmcnt(7)
L_f214:
    buffer_load_dwordx4 v[112:115], v1, s[36:39], s80 offen offset:2048 nt
    v_mfma_f32_16x16x32_bf16 v[68:71], v[76:79], v[244:247], v[68:71]
    v_and_b32_dpp v72, v33, v16 row_newbcast:0 row_mask:0xf bank_mask:0xf
    v_and_b32_dpp v73, v33, v17 row_newbcast:0 row_mask:0xf bank_mask:0xf
    v_and_b32_dpp v74, v33, v18 row_newbcast:0 row_mask:0xf bank_mask:0xf
    v_and_b32_dpp v75, v33, v19 row_newbcast:0 row_mask:0xf bank_mask:0xf
    s_waitcnt vmcnt(10)
    s_cmp_ge_u32 s27, 52
    s_cbranch_scc1 L_f215
    s_waitcnt vmcnt(7)
L_f215:
    buffer_load_dwordx4 v[116:119], v1, s[36:39], s80 offen offset:3072 nt
    v_mfma_f32_16x16x32_bf16 v[68:71], v[72:75], v[248:251], v[68:71]
    v_and_b32_dpp v76, v33, v16 row_newbcast:4 row_mask:0xf bank_mask:0xf
    v_and_b32_dpp v77, v33, v17 row_newbcast:4 row_mask:0xf bank_mask:0xf
    v_and_b32_dpp v78, v33, v18 row_newbcast:4 row_mask:0xf bank_mask:0xf
    v_and_b32_dpp v79, v33, v19 row_newbcast:4 row_mask:0xf bank_mask:0xf
    s_mov_b32 s80, 688128
    s_waitcnt vmcnt(9)
    s_cmp_ge_u32 s27, 56
    s_cbranch_scc1 L_f216
    s_waitcnt vmcnt(7)
L_f216:
    buffer_load_dwordx4 v[120:123], v1, s[36:39], s80 offen offset:0 nt
    v_mfma_f32_16x16x32_bf16 v[68:71], v[76:79], v[252:255], v[68:71]
    v_and_b32_dpp v72, v33, v16 row_newbcast:8 row_mask:0xf bank_mask:0xf
    v_and_b32_dpp v73, v33, v17 row_newbcast:8 row_mask:0xf bank_mask:0xf
    v_and_b32_dpp v74, v33, v18 row_newbcast:8 row_mask:0xf bank_mask:0xf
    v_and_b32_dpp v75, v33, v19 row_newbcast:8 row_mask:0xf bank_mask:0xf
    s_waitcnt vmcnt(9)
    s_cmp_ge_u32 s27, 59
    s_cbranch_scc1 L_f217
    s_waitcnt vmcnt(7)
L_f217:
    buffer_load_dwordx4 v[124:127], v1, s[36:39], s80 offen offset:1024 nt
    v_mfma_f32_16x16x32_bf16 v[68:71], v[72:75], v[168:171], v[68:71]
    v_and_b32_dpp v76, v33, v16 row_newbcast:12 row_mask:0xf bank_mask:0xf
    v_and_b32_dpp v77, v33, v17 row_newbcast:12 row_mask:0xf bank_mask:0xf
    v_and_b32_dpp v78, v33, v18 row_newbcast:12 row_mask:0xf bank_mask:0xf
    v_and_b32_dpp v79, v33, v19 row_newbcast:12 row_mask:0xf bank_mask:0xf
    s_add_u32 s81, s81, 73728
    buffer_load_dwordx4 a[212:215], v4, s[44:47], s81 offen offset:0
    s_waitcnt vmcnt(10)
    s_cmp_ge_u32 s27, 62
    s_cbranch_scc1 L_f218
    s_waitcnt vmcnt(7)
L_f218:
    buffer_load_dwordx4 v[128:131], v1, s[36:39], s80 offen offset:2048 nt
    v_mfma_f32_16x16x32_bf16 v[68:71], v[76:79], v[172:175], v[68:71]
    v_and_b32_dpp v72, v33, v16 row_newbcast:1 row_mask:0xf bank_mask:0xf
    v_and_b32_dpp v73, v33, v17 row_newbcast:1 row_mask:0xf bank_mask:0xf
    v_and_b32_dpp v74, v33, v18 row_newbcast:1 row_mask:0xf bank_mask:0xf
    v_and_b32_dpp v75, v33, v19 row_newbcast:1 row_mask:0xf bank_mask:0xf
    s_waitcnt vmcnt(10)
    s_cmp_ge_u32 s27, 66
    s_cbranch_scc1 L_f219
    s_waitcnt vmcnt(5)
L_f219:
    buffer_load_dwordx4 v[132:135], v1, s[36:39], s80 offen offset:3072 nt
    v_mfma_f32_16x16x32_bf16 v[68:71], v[72:75], v[176:179], v[68:71]
    v_and_b32_dpp v76, v33, v16 row_newbcast:5 row_mask:0xf bank_mask:0xf
    v_and_b32_dpp v77, v33, v17 row_newbcast:5 row_mask:0xf bank_mask:0xf
    v_and_b32_dpp v78, v33, v18 row_newbcast:5 row_mask:0xf bank_mask:0xf
    v_and_b32_dpp v79, v33, v19 row_newbcast:5 row_mask:0xf bank_mask:0xf
    s_mov_b32 s80, 704512
    s_waitcnt vmcnt(9)
    s_cmp_ge_u32 s27, 69
    s_cbranch_scc1 L_f220
    s_waitcnt vmcnt(5)
L_f220:
    buffer_load_dwordx4 v[136:139], v1, s[36:39], s80 offen offset:0 nt
    v_mfma_f32_16x16x32_bf16 v[68:71], v[76:79], v[180:183], v[68:71]
    v_and_b32_dpp v72, v33, v16 row_newbcast:9 row_mask:0xf bank_mask:0xf
    v_and_b32_dpp v73, v33, v17 row_newbcast:9 row_mask:0xf bank_mask:0xf
    v_and_b32_dpp v74, v33, v18 row_newbcast:9 row_mask:0xf bank_mask:0xf
    v_and_b32_dpp v75, v33, v19 row_newbcast:9 row_mask:0xf bank_mask:0xf
    s_waitcnt vmcnt(7)
    s_cmp_ge_u32 s27, 72
    s_cbranch_scc1 L_f221
    s_waitcnt vmcnt(5)
L_f221:
    buffer_load_dwordx4 v[140:143], v1, s[36:39], s80 offen offset:1024 nt
    v_subrev_u32 v48, s95, v48
    v_and_b32 v48, 0xfffff0ff, v48
    v_subrev_u32 v48, 18, v48
    v_cmp_gt_u32 vcc, 64, v48
    s_nop 0
    s_bcnt1_i32_b64 s27, vcc
    s_add_u32 s27, s27, s23
    s_max_i32 s27, s27, 0
    v_mfma_f32_16x16x32_bf16 v[68:71], v[72:75], v[112:115], v[68:71]
    v_and_b32_dpp v76, v33, v16 row_newbcast:13 row_mask:0xf bank_mask:0xf
    v_and_b32_dpp v77, v33, v17 row_newbcast:13 row_mask:0xf bank_mask:0xf
    v_and_b32_dpp v78, v33, v18 row_newbcast:13 row_mask:0xf bank_mask:0xf
    v_and_b32_dpp v79, v33, v19 row_newbcast:13 row_mask:0xf bank_mask:0xf
    buffer_load_dwordx4 a[220:223], v4, s[44:47], s81 offen offset:128
    s_waitcnt vmcnt(8)
    s_cmp_ge_u32 s27, 36
    s_cbranch_scc1 L_f222
    s_waitcnt vmcnt(6)
L_f222:
    buffer_load_dwordx4 v[144:147], v1, s[36:39], s80 offen offset:2048 nt
    v_mfma_f32_16x16x32_bf16 v[68:71], v[76:79], v[116:119], v[68:71]
    v_and_b32_dpp v72, v33, v16 row_newbcast:2 row_mask:0xf bank_mask:0xf
    v_and_b32_dpp v73, v33, v17 row_newbcast:2 row_mask:0xf bank_mask:0xf
    v_and_b32_dpp v74, v33, v18 row_newbcast:2 row_mask:0xf bank_mask:0xf
    v_and_b32_dpp v75, v33, v19 row_newbcast:2 row_mask:0xf bank_mask:0xf
    s_waitcnt vmcnt(8)
    s_cmp_ge_u32 s27, 39
    s_cbranch_scc1 L_f223
    s_waitcnt vmcnt(5)
L_f223:
    buffer_load_dwordx4 v[148:151], v1, s[36:39], s80 offen offset:3072 nt
    s_lshr_b32 s90, s14, 2
    s_lshl_b32 s90, s90, 8
    s_add_u32 s90, s90, 0x90000
    v_and_b32 v60, 15, v0
    v_lshl_add_u32 v63, v60, 4, s90
    buffer_load_dwordx4 v[50:53], v63, s[68:71], 0 offen
    v_mfma_f32_16x16x32_bf16 v[68:71], v[72:75], v[120:123], v[68:71]
    v_and_b32_dpp v76, v33, v16 row_newbcast:6 row_mask:0xf bank_mask:0xf
    v_and_b32_dpp v77, v33, v17 row_newbcast:6 row_mask:0xf bank_mask:0xf
    v_and_b32_dpp v78, v33, v18 row_newbcast:6 row_mask:0xf bank_mask:0xf
    v_and_b32_dpp v79, v33, v19 row_newbcast:6 row_mask:0xf bank_mask:0xf
    s_mov_b32 s80, 786432
    s_waitcnt vmcnt(9)
    s_cmp_ge_u32 s27, 43
    s_cbranch_scc1 L_f224
    s_waitcnt vmcnt(6)
L_f224:
    buffer_load_dwordx4 v[152:155], v1, s[36:39], s80 offen offset:0 nt
    v_mfma_f32_16x16x32_bf16 v[68:71], v[76:79], v[124:127], v[68:71]
    v_and_b32_dpp v72, v33, v16 row_newbcast:10 row_mask:0xf bank_mask:0xf
    v_and_b32_dpp v73, v33, v17 row_newbcast:10 row_mask:0xf bank_mask:0xf
    v_and_b32_dpp v74, v33, v18 row_newbcast:10 row_mask:0xf bank_mask:0xf
    v_and_b32_dpp v75, v33, v19 row_newbcast:10 row_mask:0xf bank_mask:0xf
    s_waitcnt vmcnt(8)
    s_cmp_ge_u32 s27, 46
    s_cbranch_scc1 L_f225
    s_waitcnt vmcnt(6)
L_f225:
    buffer_load_dwordx4 v[156:159], v1, s[36:39], s80 offen offset:1024 nt
    v_add_u32 v45, 1, v45
    buffer_store_dword v45, v46, s[68:71], 0 offen
    buffer_load_dword v48, v47, s[68:71], 0 offen nt
    v_mfma_f32_16x16x32_bf16 v[68:71], v[72:75], v[128:131], v[68:71]
    v_and_b32_dpp v76, v33, v16 row_newbcast:14 row_mask:0xf bank_mask:0xf
    v_and_b32_dpp v77, v33, v17 row_newbcast:14 row_mask:0xf bank_mask:0xf
    v_and_b32_dpp v78, v33, v18 row_newbcast:14 row_mask:0xf bank_mask:0xf
    v_and_b32_dpp v79, v33, v19 row_newbcast:14 row_mask:0xf bank_mask:0xf
    s_waitcnt vmcnt(10)
    s_cmp_ge_u32 s27, 49
    s_cbranch_scc1 L_f226
    s_waitcnt vmcnt(8)
L_f226:
    buffer_load_dwordx4 v[160:163], v1, s[36:39], s80 offen offset:2048 nt
    v_mfma_f32_16x16x32_bf16 v[68:71], v[76:79], v[132:135], v[68:71]
    v_and_b32_dpp v72, v33, v16 row_newbcast:3 row_mask:0xf bank_mask:0xf
    v_and_b32_dpp v73, v33, v17 row_newbcast:3 row_mask:0xf bank_mask:0xf
    v_and_b32_dpp v74, v33, v18 row_newbcast:3 row_mask:0xf bank_mask:0xf
    v_and_b32_dpp v75, v33, v19 row_newbcast:3 row_mask:0xf bank_mask:0xf
    s_lshl1_add_u32 s81, s3, 7
    s_and_b32 s81, s81, 7
    s_mulk_i32 s81, 4608
    buffer_load_dwordx4 a[224:227], v4, s[44:47], s81 offen offset:0
    s_waitcnt vmcnt(11)
    s_cmp_ge_u32 s27, 52
    s_cbranch_scc1 L_f227
    s_waitcnt vmcnt(8)
L_f227:
    buffer_load_dwordx4 v[164:167], v1, s[36:39], s80 offen offset:3072 nt
    v_mfma_f32_16x16x32_bf16 v[68:71], v[72:75], v[136:139], v[68:71]
    v_and_b32_dpp v76, v33, v16 row_newbcast:7 row_mask:0xf bank_mask:0xf
    v_and_b32_dpp v77, v33, v17 row_newbcast:7 row_mask:0xf bank_mask:0xf
    v_and_b32_dpp v78, v33, v18 row_newbcast:7 row_mask:0xf bank_mask:0xf
    v_and_b32_dpp v79, v33, v19 row_newbcast:7 row_mask:0xf bank_mask:0xf
    s_mov_b32 s80, 802816
    s_waitcnt vmcnt(11)
    s_cmp_ge_u32 s27, 56
    s_cbranch_scc1 L_f228
    s_waitcnt vmcnt(8)
L_f228:
    buffer_load_dwordx4 v[184:187], v1, s[36:39], s80 offen offset:0 nt
    v_mfma_f32_16x16x32_bf16 v[68:71], v[76:79], v[140:143], v[68:71]
    v_and_b32_dpp v72, v33, v16 row_newbcast:11 row_mask:0xf bank_mask:0xf
    v_and_b32_dpp v73, v33, v17 row_newbcast:11 row_mask:0xf bank_mask:0xf
    v_and_b32_dpp v74, v33, v18 row_newbcast:11 row_mask:0xf bank_mask:0xf
    v_and_b32_dpp v75, v33, v19 row_newbcast:11 row_mask:0xf bank_mask:0xf
    s_waitcnt vmcnt(10)
    s_cmp_ge_u32 s27, 59
    s_cbranch_scc1 L_f229
    s_waitcnt vmcnt(7)
L_f229:
    buffer_load_dwordx4 v[188:191], v1, s[36:39], s80 offen offset:1024 nt
    v_mfma_f32_16x16x32_bf16 v[68:71], v[72:75], v[144:147], v[68:71]
    v_and_b32_dpp v76, v33, v16 row_newbcast:15 row_mask:0xf bank_mask:0xf
    v_and_b32_dpp v77, v33, v17 row_newbcast:15 row_mask:0xf bank_mask:0xf
    v_and_b32_dpp v78, v33, v18 row_newbcast:15 row_mask:0xf bank_mask:0xf
    v_and_b32_dpp v79, v33, v19 row_newbcast:15 row_mask:0xf bank_mask:0xf
    s_waitcnt vmcnt(10)
    s_cmp_ge_u32 s27, 62
    s_cbranch_scc1 L_f230
    s_waitcnt vmcnt(7)
L_f230:
    buffer_load_dwordx4 v[192:195], v1, s[36:39], s80 offen offset:2048 nt
    v_mfma_f32_16x16x32_bf16 v[68:71], v[76:79], v[148:151], v[68:71]
    v_and_b32_dpp v72, v34, v16 row_newbcast:0 row_mask:0xf bank_mask:0xf
    v_and_b32_dpp v73, v34, v17 row_newbcast:0 row_mask:0xf bank_mask:0xf
    v_and_b32_dpp v74, v34, v18 row_newbcast:0 row_mask:0xf bank_mask:0xf
    v_and_b32_dpp v75, v34, v19 row_newbcast:0 row_mask:0xf bank_mask:0xf
    buffer_load_dwordx4 a[232:235], v4, s[44:47], s81 offen offset:128
    s_waitcnt vmcnt(10)
    s_cmp_ge_u32 s27, 66
    s_cbranch_scc1 L_f231
    s_waitcnt vmcnt(6)
L_f231:
    buffer_load_dwordx4 v[196:199], v1, s[36:39], s80 offen offset:3072 nt
    s_mov_b32 s92, 0x40000
L_st:
    v_xor_b32 v60, s95, v52
    v_xnor_b32 v61, s95, v53
    v_or_b32 v60, v60, v61
    v_cmp_ne_u32 vcc, 0, v60
    s_cbranch_vccz L_st_ok
    s_sub_u32 s92, s92, 1
    s_cbranch_scc1 L_st_ok
    s_sleep 1
    buffer_load_dwordx4 v[50:53], v63, s[68:71], 0 offen sc1
    s_waitcnt vmcnt(0)
    s_branch L_st
L_st_ok:
    v_mov_b32 v60, v50
    s_nop 1
    v_max_f32_dpp v60, v60, v60 row_ror:8 row_mask:0xf bank_mask:0xf
    s_nop 1
    v_max_f32_dpp v60, v60, v60 row_ror:4 row_mask:0xf bank_mask:0xf
    s_nop 1
    v_max_f32_dpp v60, v60, v60 row_ror:2 row_mask:0xf bank_mask:0xf
    s_nop 1
    v_max_f32_dpp v60, v60, v60 row_ror:1 row_mask:0xf bank_mask:0xf
    v_sub_f32 v50, v50, v60
    v_sub_f32 v61, v13, v60
    v_exp_f32 v50, v50
    v_exp_f32 v61, v61
    v_mul_f32 v50, v50, v51
    s_nop 1
    v_add_f32_dpp v50, v50, v50 row_ror:8 row_mask:0xf bank_mask:0xf
    s_nop 1
    v_add_f32_dpp v50, v50, v50 row_ror:4 row_mask:0xf bank_mask:0xf
    s_nop 1
    v_add_f32_dpp v50, v50, v50 row_ror:2 row_mask:0xf bank_mask:0xf
    s_nop 1
    v_add_f32_dpp v50, v50, v50 row_ror:1 row_mask:0xf bank_mask:0xf
    v_rcp_f32 v50, v50
    v_mul_f32 v61, v61, v12
    v_mul_f32 v14, v61, v50
    v_mfma_f32_16x16x32_bf16 v[68:71], v[72:75], v[152:155], v[68:71]
    v_and_b32_dpp v76, v34, v16 row_newbcast:4 row_mask:0xf bank_mask:0xf
    v_and_b32_dpp v77, v34, v17 row_newbcast:4 row_mask:0xf bank_mask:0xf
    v_and_b32_dpp v78, v34, v18 row_newbcast:4 row_mask:0xf bank_mask:0xf
    v_and_b32_dpp v79, v34, v19 row_newbcast:4 row_mask:0xf bank_mask:0xf
    s_mov_b32 s80, 819200
    s_waitcnt vmcnt(10)
    s_cmp_ge_u32 s27, 69
    s_cbranch_scc1 L_f232
    s_waitcnt vmcnt(5)
L_f232:
    buffer_load_dwordx4 v[200:203], v1, s[36:39], s80 offen offset:0 nt
    s_lshl_b32 s90, s3, 2
    v_add_u32 v24, s90, v0
    v_and_b32 v24, 15, v24
    v_and_b32 v25, 48, v0
    v_add_lshl_u32 v2, v24, v25, 3
    v_lshrrev_b32 v24, 3, v0
    v_and_b32 v25, 7, v0
    s_and_b32 s90, s3, 3
    s_lshl_b32 s90, s90, 6
    v_lshl_add_u32 v25, v25, 3, s90
    v_lshl_add_u32 v3, v24, 8, v25
    s_lshr_b32 s19, s2, 5
    s_and_b32 s90, s2, 7
    s_lshl3_add_u32 s19, s19, s90
    s_bfe_u32 s90, s2, 0x20003
    s_lshl2_add_u32 s19, s19, s90
    s_lshl_b32 s90, s3, 8
    s_add_u32 s19, s19, s90
    s_cmp_ge_u32 s19, 72
    s_cselect_b32 s90, 292608, 0
    s_lshl_b32 s91, s19, 5
    s_add_u32 s90, s90, s91
    v_and_b32 v25, 1, v0
    v_lshl_add_u32 v62, v25, 4, s90
    v_lshrrev_b32 v24, 1, v0
    s_movk_i32 s91, 2304
    v_mad_u32_u24 v62, v24, s91, v62
    v_lshrrev_b32 v24, 4, v0
    v_lshl_add_u32 v24, v25, 2, v24
    s_lshl_b32 s90, s19, 4
    v_lshl_add_u32 v25, v24, 1, s90
    v_and_b32 v24, 14, v0
    v_cmp_eq_u32 vcc, 0, v24
    s_nop 1
    v_cndmask_b32 v109, v15, v25, vcc
    s_mov_b32 s16, 73728
    s_mov_b32 s17, 147456
    s_mov_b32 s18, 221184
    s_lshl_b32 s20, s3, 8
    s_add_u32 s20, s20, s2
    v_mfma_f32_16x16x32_bf16 v[68:71], v[76:79], v[156:159], v[68:71]
    v_and_b32_dpp v72, v34, v16 row_newbcast:8 row_mask:0xf bank_mask:0xf
    v_and_b32_dpp v73, v34, v17 row_newbcast:8 row_mask:0xf bank_mask:0xf
    v_and_b32_dpp v74, v34, v18 row_newbcast:8 row_mask:0xf bank_mask:0xf
    v_and_b32_dpp v75, v34, v19 row_newbcast:8 row_mask:0xf bank_mask:0xf
    s_waitcnt vmcnt(8)
    s_cmp_ge_u32 s27, 72
    s_cbranch_scc1 L_f233
    s_waitcnt vmcnt(5)
L_f233:
    buffer_load_dwordx4 v[204:207], v1, s[36:39], s80 offen offset:1024 nt
    v_subrev_u32 v48, s95, v48
    v_and_b32 v48, 0xfffff0ff, v48
    v_subrev_u32 v48, 19, v48
    v_cmp_gt_u32 vcc, 64, v48
    s_nop 0
    s_bcnt1_i32_b64 s27, vcc
    s_add_u32 s27, s27, s23
    s_max_i32 s27, s27, 0
    v_mfma_f32_16x16x32_bf16 v[68:71], v[72:75], v[160:163], v[68:71]
    v_and_b32_dpp v76, v34, v16 row_newbcast:12 row_mask:0xf bank_mask:0xf
    v_and_b32_dpp v77, v34, v17 row_newbcast:12 row_mask:0xf bank_mask:0xf
    v_and_b32_dpp v78, v34, v18 row_newbcast:12 row_mask:0xf bank_mask:0xf
    v_and_b32_dpp v79, v34, v19 row_newbcast:12 row_mask:0xf bank_mask:0xf
    s_waitcnt vmcnt(7)
    s_cmp_ge_u32 s27, 36
    s_cbranch_scc1 L_f234
    s_waitcnt vmcnt(5)
L_f234:
    buffer_load_dwordx4 v[208:211], v1, s[36:39], s80 offen offset:2048 nt
    v_mfma_f32_16x16x32_bf16 v[68:71], v[76:79], v[164:167], v[68:71]
    v_and_b32_dpp v72, v34, v16 row_newbcast:1 row_mask:0xf bank_mask:0xf
    v_and_b32_dpp v73, v34, v17 row_newbcast:1 row_mask:0xf bank_mask:0xf
    v_and_b32_dpp v74, v34, v18 row_newbcast:1 row_mask:0xf bank_mask:0xf
    v_and_b32_dpp v75, v34, v19 row_newbcast:1 row_mask:0xf bank_mask:0xf
    s_waitcnt vmcnt(7)
    s_cmp_ge_u32 s27, 39
    s_cbranch_scc1 L_f235
    s_waitcnt vmcnt(5)
L_f235:
    buffer_load_dwordx4 v[212:215], v1, s[36:39], s80 offen offset:3072 nt
    v_mfma_f32_16x16x32_bf16 v[68:71], v[72:75], v[184:187], v[68:71]
    v_and_b32_dpp v76, v34, v16 row_newbcast:5 row_mask:0xf bank_mask:0xf
    v_and_b32_dpp v77, v34, v17 row_newbcast:5 row_mask:0xf bank_mask:0xf
    v_and_b32_dpp v78, v34, v18 row_newbcast:5 row_mask:0xf bank_mask:0xf
    v_and_b32_dpp v79, v34, v19 row_newbcast:5 row_mask:0xf bank_mask:0xf
    s_add_u32 s81, s81, 73728
    buffer_load_dwordx4 a[228:231], v4, s[44:47], s81 offen offset:0
    s_mov_b32 s80, 835584
    s_waitcnt vmcnt(8)
    s_cmp_ge_u32 s27, 43
    s_cbranch_scc1 L_f236
    s_waitcnt vmcnt(5)
L_f236:
    buffer_load_dwordx4 v[216:219], v1, s[36:39], s80 offen offset:0 nt
    v_mfma_f32_16x16x32_bf16 v[68:71], v[76:79], v[188:191], v[68:71]
    v_and_b32_dpp v72, v34, v16 row_newbcast:9 row_mask:0xf bank_mask:0xf
    v_and_b32_dpp v73, v34, v17 row_newbcast:9 row_mask:0xf bank_mask:0xf
    v_and_b32_dpp v74, v34, v18 row_newbcast:9 row_mask:0xf bank_mask:0xf
    v_and_b32_dpp v75, v34, v19 row_newbcast:9 row_mask:0xf bank_mask:0xf
    s_waitcnt vmcnt(8)
    s_cmp_ge_u32 s27, 46
    s_cbranch_scc1 L_f237
    s_waitcnt vmcnt(5)
L_f237:
    buffer_load_dwordx4 v[220:223], v1, s[36:39], s80 offen offset:1024 nt
    v_add_u32 v45, 1, v45
    buffer_store_dword v45, v46, s[68:71], 0 offen
    buffer_load_dword v48, v47, s[68:71], 0 offen nt
    v_mfma_f32_16x16x32_bf16 v[68:71], v[72:75], v[192:195], v[68:71]
    v_and_b32_dpp v76, v34, v16 row_newbcast:13 row_mask:0xf bank_mask:0xf
    v_and_b32_dpp v77, v34, v17 row_newbcast:13 row_mask:0xf bank_mask:0xf
    v_and_b32_dpp v78, v34, v18 row_newbcast:13 row_mask:0xf bank_mask:0xf
    v_and_b32_dpp v79, v34, v19 row_newbcast:13 row_mask:0xf bank_mask:0xf
    s_waitcnt vmcnt(9)
    s_cmp_ge_u32 s27, 49
    s_cbranch_scc1 L_f238
    s_waitcnt vmcnt(7)
L_f238:
    buffer_load_dwordx4 v[224:227], v1, s[36:39], s80 offen offset:2048 nt
    v_mfma_f32_16x16x32_bf16 v[68:71], v[76:79], v[196:199], v[68:71]
    v_and_b32_dpp v72, v34, v16 row_newbcast:2 row_mask:0xf bank_mask:0xf
    v_and_b32_dpp v73, v34, v17 row_newbcast:2 row_mask:0xf bank_mask:0xf
    v_and_b32_dpp v74, v34, v18 row_newbcast:2 row_mask:0xf bank_mask:0xf
    v_and_b32_dpp v75, v34, v19 row_newbcast:2 row_mask:0xf bank_mask:0xf
    s_waitcnt vmcnt(9)
    s_cmp_ge_u32 s27, 52
    s_cbranch_scc1 L_f239
    s_waitcnt vmcnt(7)
L_f239:
    buffer_load_dwordx4 v[228:231], v1, s[36:39], s80 offen offset:3072 nt
    v_mfma_f32_16x16x32_bf16 v[68:71], v[72:75], v[200:203], v[68:71]
    v_and_b32_dpp v76, v34, v16 row_newbcast:6 row_mask:0xf bank_mask:0xf
    v_and_b32_dpp v77, v34, v17 row_newbcast:6 row_mask:0xf bank_mask:0xf
    v_and_b32_dpp v78, v34, v18 row_newbcast:6 row_mask:0xf bank_mask:0xf
    v_and_b32_dpp v79, v34, v19 row_newbcast:6 row_mask:0xf bank_mask:0xf
    buffer_load_dwordx4 a[236:239], v4, s[44:47], s81 offen offset:128
    s_mov_b32 s80, 917504
    s_waitcnt vmcnt(10)
    s_cmp_ge_u32 s27, 56
    s_cbranch_scc1 L_f240
    s_waitcnt vmcnt(8)
L_f240:
    buffer_load_dwordx4 v[232:235], v1, s[36:39], s80 offen offset:0 nt
    v_mfma_f32_16x16x32_bf16 v[68:71], v[76:79], v[204:207], v[68:71]
    v_and_b32_dpp v72, v34, v16 row_newbcast:10 row_mask:0xf bank_mask:0xf
    v_and_b32_dpp v73, v34, v17 row_newbcast:10 row_mask:0xf bank_mask:0xf
    v_and_b32_dpp v74, v34, v18 row_newbcast:10 row_mask:0xf bank_mask:0xf
    v_and_b32_dpp v75, v34, v19 row_newbcast:10 row_mask:0xf bank_mask:0xf
    s_waitcnt vmcnt(10)
    s_cmp_ge_u32 s27, 59
    s_cbranch_scc1 L_f241
    s_waitcnt vmcnt(7)
L_f241:
    buffer_load_dwordx4 v[236:239], v1, s[36:39], s80 offen offset:1024 nt
    v_mfma_f32_16x16x32_bf16 v[68:71], v[72:75], v[208:211], v[68:71]
    v_and_b32_dpp v76, v34, v16 row_newbcast:14 row_mask:0xf bank_mask:0xf
    v_and_b32_dpp v77, v34, v17 row_newbcast:14 row_mask:0xf bank_mask:0xf
    v_and_b32_dpp v78, v34, v18 row_newbcast:14 row_mask:0xf bank_mask:0xf
    v_and_b32_dpp v79, v34, v19 row_newbcast:14 row_mask:0xf bank_mask:0xf
    s_waitcnt vmcnt(10)
    s_cmp_ge_u32 s27, 62
    s_cbranch_scc1 L_f242
    s_waitcnt vmcnt(7)
L_f242:
    buffer_load_dwordx4 v[240:243], v1, s[36:39], s80 offen offset:2048 nt
    v_mfma_f32_16x16x32_bf16 v[68:71], v[76:79], v[212:215], v[68:71]
    v_and_b32_dpp v72, v34, v16 row_newbcast:3 row_mask:0xf bank_mask:0xf
    v_and_b32_dpp v73, v34, v17 row_newbcast:3 row_mask:0xf bank_mask:0xf
    v_and_b32_dpp v74, v34, v18 row_newbcast:3 row_mask:0xf bank_mask:0xf
    v_and_b32_dpp v75, v34, v19 row_newbcast:3 row_mask:0xf bank_mask:0xf
    s_waitcnt vmcnt(9)
    s_cmp_ge_u32 s27, 66
    s_cbranch_scc1 L_f243
    s_waitcnt vmcnt(5)
L_f243:
    buffer_load_dwordx4 v[244:247], v1, s[36:39], s80 offen offset:3072 nt
    v_mfma_f32_16x16x32_bf16 v[68:71], v[72:75], v[216:219], v[68:71]
    v_and_b32_dpp v76, v34, v16 row_newbcast:7 row_mask:0xf bank_mask:0xf
    v_and_b32_dpp v77, v34, v17 row_newbcast:7 row_mask:0xf bank_mask:0xf
    v_and_b32_dpp v78, v34, v18 row_newbcast:7 row_mask:0xf bank_mask:0xf
    v_and_b32_dpp v79, v34, v19 row_newbcast:7 row_mask:0xf bank_mask:0xf
    s_mov_b32 s80, 933888
    s_waitcnt vmcnt(9)
    s_cmp_ge_u32 s27, 69
    s_cbranch_scc1 L_f244
    s_waitcnt vmcnt(5)
L_f244:
    buffer_load_dwordx4 v[248:251], v1, s[36:39], s80 offen offset:0 nt
    v_mfma_f32_16x16x32_bf16 v[68:71], v[76:79], v[220:223], v[68:71]
    v_and_b32_dpp v72, v34, v16 row_newbcast:11 row_mask:0xf bank_mask:0xf
    v_and_b32_dpp v73, v34, v17 row_newbcast:11 row_mask:0xf bank_mask:0xf
    v_and_b32_dpp v74, v34, v18 row_newbcast:11 row_mask:0xf bank_mask:0xf
    v_and_b32_dpp v75, v34, v19 row_newbcast:11 row_mask:0xf bank_mask:0xf
    s_waitcnt vmcnt(7)
    s_cmp_ge_u32 s27, 72
    s_cbranch_scc1 L_f245
    s_waitcnt vmcnt(4)
L_f245:
    buffer_load_dwordx4 v[252:255], v1, s[36:39], s80 offen offset:1024 nt
    v_subrev_u32 v48, s95, v48
    v_and_b32 v48, 0xfffff0ff, v48
    v_subrev_u32 v48, 20, v48
    v_cmp_gt_u32 vcc, 64, v48
    s_nop 0
    s_bcnt1_i32_b64 s27, vcc
    s_add_u32 s27, s27, s23
    s_max_i32 s27, s27, 0
    v_mfma_f32_16x16x32_bf16 v[68:71], v[72:75], v[224:227], v[68:71]
    v_and_b32_dpp v76, v34, v16 row_newbcast:15 row_mask:0xf bank_mask:0xf
    v_and_b32_dpp v77, v34, v17 row_newbcast:15 row_mask:0xf bank_mask:0xf
    v_and_b32_dpp v78, v34, v18 row_newbcast:15 row_mask:0xf bank_mask:0xf
    v_and_b32_dpp v79, v34, v19 row_newbcast:15 row_mask:0xf bank_mask:0xf
    s_waitcnt vmcnt(7)
    s_cmp_ge_u32 s27, 36
    s_cbranch_scc1 L_f246
    s_waitcnt vmcnt(4)
L_f246:
    buffer_load_dwordx4 v[168:171], v1, s[36:39], s80 offen offset:2048 nt
    v_mfma_f32_16x16x32_bf16 v[68:71], v[76:79], v[228:231], v[68:71]
    v_and_b32_dpp v72, v35, v16 row_newbcast:0 row_mask:0xf bank_mask:0xf
    v_and_b32_dpp v73, v35, v17 row_newbcast:0 row_mask:0xf bank_mask:0xf
    v_and_b32_dpp v74, v35, v18 row_newbcast:0 row_mask:0xf bank_mask:0xf
    v_and_b32_dpp v75, v35, v19 row_newbcast:0 row_mask:0xf bank_mask:0xf
    s_waitcnt vmcnt(6)
    s_cmp_ge_u32 s27, 39
    s_cbranch_scc1 L_f247
    s_waitcnt vmcnt(4)
L_f247:
    buffer_load_dwordx4 v[172:175], v1, s[36:39], s80 offen offset:3072 nt
    v_mfma_f32_16x16x32_bf16 v[68:71], v[72:75], v[232:235], v[68:71]
    v_and_b32_dpp v76, v35, v16 row_newbcast:4 row_mask:0xf bank_mask:0xf
    v_and_b32_dpp v77, v35, v17 row_newbcast:4 row_mask:0xf bank_mask:0xf
    v_and_b32_dpp v78, v35, v18 row_newbcast:4 row_mask:0xf bank_mask:0xf
    v_and_b32_dpp v79, v35, v19 row_newbcast:4 row_mask:0xf bank_mask:0xf
    s_mov_b32 s80, 950272
    s_waitcnt vmcnt(6)
    s_cmp_ge_u32 s27, 43
    s_cbranch_scc1 L_f248
    s_waitcnt vmcnt(4)
L_f248:
    buffer_load_dwordx4 v[176:179], v1, s[36:39], s80 offen offset:0 nt
    v_mfma_f32_16x16x32_bf16 v[68:71], v[76:79], v[236:239], v[68:71]
    v_and_b32_dpp v72, v35, v16 row_newbcast:8 row_mask:0xf bank_mask:0xf
    v_and_b32_dpp v73, v35, v17 row_newbcast:8 row_mask:0xf bank_mask:0xf
    v_and_b32_dpp v74, v35, v18 row_newbcast:8 row_mask:0xf bank_mask:0xf
    v_and_b32_dpp v75, v35, v19 row_newbcast:8 row_mask:0xf bank_mask:0xf
    s_waitcnt vmcnt(6)
    s_cmp_ge_u32 s27, 46
    s_cbranch_scc1 L_f249
    s_waitcnt vmcnt(4)
L_f249:
    buffer_load_dwordx4 v[180:183], v1, s[36:39], s80 offen offset:1024 nt
    v_mfma_f32_16x16x32_bf16 v[68:71], v[72:75], v[240:243], v[68:71]
    v_and_b32_dpp v76, v35, v16 row_newbcast:12 row_mask:0xf bank_mask:0xf
    v_and_b32_dpp v77, v35, v17 row_newbcast:12 row_mask:0xf bank_mask:0xf
    v_and_b32_dpp v78, v35, v18 row_newbcast:12 row_mask:0xf bank_mask:0xf
    v_and_b32_dpp v79, v35, v19 row_newbcast:12 row_mask:0xf bank_mask:0xf
    s_waitcnt vmcnt(6)
    s_cmp_ge_u32 s27, 49
    s_cbranch_scc1 L_f250
    s_waitcnt vmcnt(4)
L_f250:
    buffer_load_dwordx4 v[112:115], v1, s[36:39], s80 offen offset:2048 nt
    v_mfma_f32_16x16x32_bf16 v[68:71], v[76:79], v[244:247], v[68:71]
    v_and_b32_dpp v72, v35, v16 row_newbcast:1 row_mask:0xf bank_mask:0xf
    v_and_b32_dpp v73, v35, v17 row_newbcast:1 row_mask:0xf bank_mask:0xf
    v_and_b32_dpp v74, v35, v18 row_newbcast:1 row_mask:0xf bank_mask:0xf
    v_and_b32_dpp v75, v35, v19 row_newbcast:1 row_mask:0xf bank_mask:0xf
    s_waitcnt vmcnt(6)
    s_cmp_ge_u32 s27, 52
    s_cbranch_scc1 L_f251
    s_waitcnt vmcnt(4)
L_f251:
    buffer_load_dwordx4 v[116:119], v1, s[36:39], s80 offen offset:3072 nt
    v_mfma_f32_16x16x32_bf16 v[68:71], v[72:75], v[248:251], v[68:71]
    v_and_b32_dpp v76, v35, v16 row_newbcast:5 row_mask:0xf bank_mask:0xf
    v_and_b32_dpp v77, v35, v17 row_newbcast:5 row_mask:0xf bank_mask:0xf
    v_and_b32_dpp v78, v35, v18 row_newbcast:5 row_mask:0xf bank_mask:0xf
    v_and_b32_dpp v79, v35, v19 row_newbcast:5 row_mask:0xf bank_mask:0xf
    s_mov_b32 s80, 966656
    buffer_load_dwordx4 v[120:123], v1, s[36:39], s80 offen offset:0 nt
    s_waitcnt vmcnt(7)
    buffer_load_dwordx4 v[124:127], v1, s[36:39], s80 offen offset:1024 nt
    v_mfma_f32_16x16x32_bf16 v[68:71], v[76:79], v[252:255], v[68:71]
    v_and_b32_dpp v72, v35, v16 row_newbcast:9 row_mask:0xf bank_mask:0xf
    v_and_b32_dpp v73, v35, v17 row_newbcast:9 row_mask:0xf bank_mask:0xf
    v_and_b32_dpp v74, v35, v18 row_newbcast:9 row_mask:0xf bank_mask:0xf
    v_and_b32_dpp v75, v35, v19 row_newbcast:9 row_mask:0xf bank_mask:0xf
    s_waitcnt vmcnt(7)
    buffer_load_dwordx4 v[128:131], v1, s[36:39], s80 offen offset:2048 nt
    v_mfma_f32_16x16x32_bf16 v[68:71], v[72:75], v[168:171], v[68:71]
    v_and_b32_dpp v76, v35, v16 row_newbcast:13 row_mask:0xf bank_mask:0xf
    v_and_b32_dpp v77, v35, v17 row_newbcast:13 row_mask:0xf bank_mask:0xf
    v_and_b32_dpp v78, v35, v18 row_newbcast:13 row_mask:0xf bank_mask:0xf
    v_and_b32_dpp v79, v35, v19 row_newbcast:13 row_mask:0xf bank_mask:0xf
    s_waitcnt vmcnt(7)
    buffer_load_dwordx4 v[132:135], v1, s[36:39], s80 offen offset:3072 nt
    v_mfma_f32_16x16x32_bf16 v[68:71], v[76:79], v[172:175], v[68:71]
    v_and_b32_dpp v72, v35, v16 row_newbcast:2 row_mask:0xf bank_mask:0xf
    v_and_b32_dpp v73, v35, v17 row_newbcast:2 row_mask:0xf bank_mask:0xf
    v_and_b32_dpp v74, v35, v18 row_newbcast:2 row_mask:0xf bank_mask:0xf
    v_and_b32_dpp v75, v35, v19 row_newbcast:2 row_mask:0xf bank_mask:0xf
    s_waitcnt vmcnt(7)
    s_nop 0
    v_mfma_f32_16x16x32_bf16 v[68:71], v[72:75], v[176:179], v[68:71]
    v_and_b32_dpp v76, v35, v16 row_newbcast:6 row_mask:0xf bank_mask:0xf
    v_and_b32_dpp v77, v35, v17 row_newbcast:6 row_mask:0xf bank_mask:0xf
    v_and_b32_dpp v78, v35, v18 row_newbcast:6 row_mask:0xf bank_mask:0xf
    v_and_b32_dpp v79, v35, v19 row_newbcast:6 row_mask:0xf bank_mask:0xf
    s_waitcnt vmcnt(6)
    s_nop 0
    v_mfma_f32_16x16x32_bf16 v[68:71], v[76:79], v[180:183], v[68:71]
    v_and_b32_dpp v72, v35, v16 row_newbcast:10 row_mask:0xf bank_mask:0xf
    v_and_b32_dpp v73, v35, v17 row_newbcast:10 row_mask:0xf bank_mask:0xf
    v_and_b32_dpp v74, v35, v18 row_newbcast:10 row_mask:0xf bank_mask:0xf
    v_and_b32_dpp v75, v35, v19 row_newbcast:10 row_mask:0xf bank_mask:0xf
    s_waitcnt vmcnt(5)
    s_nop 0
    v_mfma_f32_16x16x32_bf16 v[68:71], v[72:75], v[112:115], v[68:71]
    v_and_b32_dpp v76, v35, v16 row_newbcast:14 row_mask:0xf bank_mask:0xf
    v_and_b32_dpp v77, v35, v17 row_newbcast:14 row_mask:0xf bank_mask:0xf
    v_and_b32_dpp v78, v35, v18 row_newbcast:14 row_mask:0xf bank_mask:0xf
    v_and_b32_dpp v79, v35, v19 row_newbcast:14 row_mask:0xf bank_mask:0xf
    s_waitcnt vmcnt(4)
    s_nop 0
    v_mfma_f32_16x16x32_bf16 v[68:71], v[76:79], v[116:119], v[68:71]
    v_and_b32_dpp v72, v35, v16 row_newbcast:3 row_mask:0xf bank_mask:0xf
    v_and_b32_dpp v73, v35, v17 row_newbcast:3 row_mask:0xf bank_mask:0xf
    v_and_b32_dpp v74, v35, v18 row_newbcast:3 row_mask:0xf bank_mask:0xf
    v_and_b32_dpp v75, v35, v19 row_newbcast:3 row_mask:0xf bank_mask:0xf
    s_waitcnt vmcnt(3)
    s_nop 0
    v_mfma_f32_16x16x32_bf16 v[68:71], v[72:75], v[120:123], v[68:71]
    v_and_b32_dpp v76, v35, v16 row_newbcast:7 row_mask:0xf bank_mask:0xf
    v_and_b32_dpp v77, v35, v17 row_newbcast:7 row_mask:0xf bank_mask:0xf
    v_and_b32_dpp v78, v35, v18 row_newbcast:7 row_mask:0xf bank_mask:0xf
    v_and_b32_dpp v79, v35, v19 row_newbcast:7 row_mask:0xf bank_mask:0xf
    s_waitcnt vmcnt(2)
    s_nop 0
    v_mfma_f32_16x16x32_bf16 v[68:71], v[76:79], v[124:127], v[68:71]
    v_and_b32_dpp v72, v35, v16 row_newbcast:11 row_mask:0xf bank_mask:0xf
    v_and_b32_dpp v73, v35, v17 row_newbcast:11 row_mask:0xf bank_mask:0xf
    v_and_b32_dpp v74, v35, v18 row_newbcast:11 row_mask:0xf bank_mask:0xf
    v_and_b32_dpp v75, v35, v19 row_newbcast:11 row_mask:0xf bank_mask:0xf
    s_waitcnt vmcnt(1)
    s_nop 0
    v_mfma_f32_16x16x32_bf16 v[68:71], v[72:75], v[128:131], v[68:71]
    v_and_b32_dpp v76, v35, v16 row_newbcast:15 row_mask:0xf bank_mask:0xf
    v_and_b32_dpp v77, v35, v17 row_newbcast:15 row_mask:0xf bank_mask:0xf
    v_and_b32_dpp v78, v35, v18 row_newbcast:15 row_mask:0xf bank_mask:0xf
    v_and_b32_dpp v79, v35, v19 row_newbcast:15 row_mask:0xf bank_mask:0xf
    s_waitcnt vmcnt(0)
    s_nop 0
    v_mfma_f32_16x16x32_bf16 v[68:71], v[76:79], v[132:135], v[68:71]
    s_nop 7
    v_mul_f32 v68, v68, v14
    v_mul_f32 v69, v69, v14
    v_mul_f32 v70, v70, v14
    v_mul_f32 v71, v71, v14
    ds_write_b128 v108, v[68:71] offset:8448
    s_waitcnt lgkmcnt(0)
    s_barrier
    ds_read_b64 v[80:81], v2 offset:8448
    ds_read_b64 v[82:83], v2 offset:8960
    ds_read_b64 v[84:85], v2 offset:9472
    ds_read_b64 v[86:87], v2 offset:9984
    buffer_load_dword v48, v47, s[68:71], 0 offen nt
    s_waitcnt lgkmcnt(2)
    v_pk_add_f32 v[80:81], v[80:81], v[82:83]
    s_waitcnt lgkmcnt(0)
    v_pk_add_f32 v[84:85], v[84:85], v[86:87]
    v_pk_add_f32 v[80:81], v[80:81], v[84:85]
    v_cvt_pk_bf16_f32 v26, v80, v81
    s_nop 1
    v_and_b32_dpp v72, v26, v20 row_newbcast:0 row_mask:0xf bank_mask:0xf
    v_and_b32_dpp v73, v26, v21 row_newbcast:0 row_mask:0xf bank_mask:0xf
    v_and_b32_dpp v74, v26, v20 row_newbcast:1 row_mask:0xf bank_mask:0xf
    v_and_b32_dpp v75, v26, v21 row_newbcast:1 row_mask:0xf bank_mask:0xf
    v_and_b32_dpp v76, v26, v20 row_newbcast:2 row_mask:0xf bank_mask:0xf
    v_and_b32_dpp v77, v26, v21 row_newbcast:2 row_mask:0xf bank_mask:0xf
    v_smfmac_f32_16x16x64_bf16 v[104:107], v[72:75], a[240:247], v22
    v_and_b32_dpp v78, v26, v20 row_newbcast:3 row_mask:0xf bank_mask:0xf
    v_and_b32_dpp v79, v26, v21 row_newbcast:3 row_mask:0xf bank_mask:0xf
    v_smfmac_f32_16x16x64_bf16 v[96:99], v[72:75], a[112:119], v22
    v_smfmac_f32_16x16x64_bf16 v[100:103], v[72:75], a[120:127], v22
    v_smfmac_f32_16x16x64_bf16 v[104:107], v[76:79], a[248:255], v22
    v_and_b32_dpp v88, v26, v20 row_newbcast:4 row_mask:0xf bank_mask:0xf
    v_and_b32_dpp v89, v26, v21 row_newbcast:4 row_mask:0xf bank_mask:0xf
    v_smfmac_f32_16x16x64_bf16 v[96:99], v[76:79], a[128:135], v22
    v_and_b32_dpp v90, v26, v20 row_newbcast:5 row_mask:0xf bank_mask:0xf
    v_and_b32_dpp v91, v26, v21 row_newbcast:5 row_mask:0xf bank_mask:0xf
    v_smfmac_f32_16x16x64_bf16 v[100:103], v[76:79], a[136:143], v22
    v_and_b32_dpp v92, v26, v20 row_newbcast:6 row_mask:0xf bank_mask:0xf
    v_and_b32_dpp v93, v26, v21 row_newbcast:6 row_mask:0xf bank_mask:0xf
    v_smfmac_f32_16x16x64_bf16 v[96:99], v[88:91], a[144:151], v22
    v_and_b32_dpp v94, v26, v20 row_newbcast:7 row_mask:0xf bank_mask:0xf
    v_and_b32_dpp v95, v26, v21 row_newbcast:7 row_mask:0xf bank_mask:0xf
    v_smfmac_f32_16x16x64_bf16 v[100:103], v[88:91], a[152:159], v22
    v_and_b32_dpp v72, v26, v20 row_newbcast:8 row_mask:0xf bank_mask:0xf
    v_and_b32_dpp v73, v26, v21 row_newbcast:8 row_mask:0xf bank_mask:0xf
    ds_write_b128 v111, v[104:107] offset:10496
    v_smfmac_f32_16x16x64_bf16 v[96:99], v[92:95], a[160:167], v22
    v_and_b32_dpp v74, v26, v20 row_newbcast:9 row_mask:0xf bank_mask:0xf
    v_and_b32_dpp v75, v26, v21 row_newbcast:9 row_mask:0xf bank_mask:0xf
    v_smfmac_f32_16x16x64_bf16 v[100:103], v[92:95], a[168:175], v22
    v_and_b32_dpp v76, v26, v20 row_newbcast:10 row_mask:0xf bank_mask:0xf
    v_and_b32_dpp v77, v26, v21 row_newbcast:10 row_mask:0xf bank_mask:0xf
    v_smfmac_f32_16x16x64_bf16 v[96:99], v[72:75], a[176:183], v22
    v_and_b32_dpp v78, v26, v20 row_newbcast:11 row_mask:0xf bank_mask:0xf
    v_and_b32_dpp v79, v26, v21 row_newbcast:11 row_mask:0xf bank_mask:0xf
    v_smfmac_f32_16x16x64_bf16 v[100:103], v[72:75], a[184:191], v22
    v_and_b32_dpp v88, v26, v20 row_newbcast:12 row_mask:0xf bank_mask:0xf
    v_and_b32_dpp v89, v26, v21 row_newbcast:12 row_mask:0xf bank_mask:0xf
    s_waitcnt lgkmcnt(0)
    s_barrier
    ds_read_b64 v[50:51], v3 offset:10496
    v_smfmac_f32_16x16x64_bf16 v[96:99], v[76:79], a[192:199], v22
    v_and_b32_dpp v90, v26, v20 row_newbcast:13 row_mask:0xf bank_mask:0xf
    v_and_b32_dpp v91, v26, v21 row_newbcast:13 row_mask:0xf bank_mask:0xf
    v_smfmac_f32_16x16x64_bf16 v[100:103], v[76:79], a[200:207], v22
    v_and_b32_dpp v92, v26, v20 row_newbcast:14 row_mask:0xf bank_mask:0xf
    v_and_b32_dpp v93, v26, v21 row_newbcast:14 row_mask:0xf bank_mask:0xf
    v_smfmac_f32_16x16x64_bf16 v[96:99], v[88:91], a[208:215], v22
    v_and_b32_dpp v94, v26, v20 row_newbcast:15 row_mask:0xf bank_mask:0xf
    v_and_b32_dpp v95, v26, v21 row_newbcast:15 row_mask:0xf bank_mask:0xf
    v_smfmac_f32_16x16x64_bf16 v[100:103], v[88:91], a[216:223], v22
    s_nop 0
    v_smfmac_f32_16x16x64_bf16 v[96:99], v[92:95], a[224:231], v22
    v_smfmac_f32_16x16x64_bf16 v[100:103], v[92:95], a[232:239], v22
    s_waitcnt lgkmcnt(0)
    v_add_f32_dpp v50, v50, v50 row_ror:8 row_mask:0xf bank_mask:0xf
    v_add_f32_dpp v51, v51, v51 row_ror:8 row_mask:0xf bank_mask:0xf
    s_nop 1
    v_permlane16_swap_b32 v50, v51
    v_add_f32 v50, v50, v51
    v_mov_b32 v51, v50
    s_nop 1
    v_permlane32_swap_b32 v50, v51
    s_nop 0
    v_permlane32_swap_b32 v96, v100
    v_permlane32_swap_b32 v97, v101
    v_permlane32_swap_b32 v98, v102
    v_permlane32_swap_b32 v99, v103
    v_add_f32 v50, v50, v51
    v_add_f32_dpp v96, v100, v96 row_ror:8 row_mask:0xf bank_mask:0xf
    v_add_f32_dpp v97, v101, v97 row_ror:8 row_mask:0xf bank_mask:0xf
    v_add_f32_dpp v98, v102, v98 row_ror:8 row_mask:0xf bank_mask:0xf
    v_add_f32_dpp v99, v103, v99 row_ror:8 row_mask:0xf bank_mask:0xf
    v_and_or_b32 v96, v96, v27, s76
    v_and_or_b32 v97, v97, v27, s77
    v_and_or_b32 v98, v98, v27, s78
    v_and_or_b32 v99, v99, v27, s79
    buffer_store_dwordx4 v[96:99], v10, s[68:71], 0 offen sc1
    v_and_or_b32 v50, v50, v27, v49
    buffer_store_dword v50, v11, s[68:71], 0 offen sc1
    s_mov_b32 s92, 0x40000
    v_add_u32 v45, 1, v45
    buffer_store_dword v45, v46, s[68:71], 0 offen
    s_cmp_ge_u32 s19, 144
    s_cbranch_scc1 L_other
    s_movk_i32 s90, 12
    s_waitcnt vmcnt(3)
    v_cmp_eq_u32 vcc, v48, v45
    s_nop 0
    s_bcnt1_i32_b64 s27, vcc
    s_cmp_ge_u32 s27, 8
    s_cbranch_scc1 L_lw_ok
L_lw:
    buffer_load_dword v48, v47, s[68:71], 0 offen nt
    s_waitcnt vmcnt(0)
    v_cmp_eq_u32 vcc, v48, v45
    s_nop 0
    s_bcnt1_i32_b64 s27, vcc
    s_cmp_ge_u32 s27, 56
    s_cbranch_scc1 L_lw_ok
    s_sub_u32 s90, s90, 1
    s_cbranch_scc0 L_lw
L_lw_ok:
    buffer_load_dwordx4 v[128:131], v62, s[68:71], 0 offen sc1
    buffer_load_dwordx4 v[132:135], v62, s[68:71], s16 offen sc1
    buffer_load_dwordx4 v[136:139], v62, s[68:71], s17 offen sc1
    buffer_load_dwordx4 v[140:143], v62, s[68:71], s18 offen sc1
    buffer_load_dwordx4 v[144:147], v62, s[68:71], 0 offen sc1
    buffer_load_dwordx4 v[148:151], v62, s[68:71], s16 offen sc1
    buffer_load_dwordx4 v[152:155], v62, s[68:71], s17 offen sc1
    buffer_load_dwordx4 v[156:159], v62, s[68:71], s18 offen sc1
L_poll:
    buffer_load_dwordx4 v[160:163], v62, s[68:71], 0 offen sc1
    buffer_load_dwordx4 v[164:167], v62, s[68:71], s16 offen sc1
    buffer_load_dwordx4 v[168:171], v62, s[68:71], s17 offen sc1
    buffer_load_dwordx4 v[172:175], v62, s[68:71], s18 offen sc1
    s_waitcnt vmcnt(11)
    v_xor_b32 v80, s76, v128
    v_xor_b32 v81, s77, v129
    v_xor_b32 v82, s78, v130
    v_xor_b32 v83, s79, v131
    v_or3_b32 v60, v80, v81, v82
    v_or_b32 v60, v60, v83
    s_waitcnt vmcnt(10)
    v_xor_b32 v84, s76, v132
    v_xor_b32 v85, s77, v133
    v_xor_b32 v86, s78, v134
    v_xor_b32 v87, s79, v135
    v_or3_b32 v60, v60, v84, v85
    v_or3_b32 v60, v60, v86, v87
    v_pk_add_f32 v[80:81], v[80:81], v[84:85]
    v_pk_add_f32 v[82:83], v[82:83], v[86:87]
    s_waitcnt vmcnt(9)
    v_xor_b32 v88, s76, v136
    v_xor_b32 v89, s77, v137
    v_xor_b32 v90, s78, v138
    v_xor_b32 v91, s79, v139
    v_or3_b32 v60, v60, v88, v89
    v_or3_b32 v60, v60, v90, v91
    s_waitcnt vmcnt(8)
    v_xor_b32 v92, s76, v140
    v_xor_b32 v93, s77, v141
    v_xor_b32 v94, s78, v142
    v_xor_b32 v95, s79, v143
    v_or3_b32 v60, v60, v92, v93
    v_or3_b32 v60, v60, v94, v95
    v_pk_add_f32 v[88:89], v[88:89], v[92:93]
    v_pk_add_f32 v[90:91], v[90:91], v[94:95]
    v_and_b32 v60, 0xff, v60
    v_cmp_ne_u32 vcc, 0, v60
    s_cbranch_vccz L_got
    buffer_load_dwordx4 v[128:131], v62, s[68:71], 0 offen sc1
    buffer_load_dwordx4 v[132:135], v62, s[68:71], s16 offen sc1
    buffer_load_dwordx4 v[136:139], v62, s[68:71], s17 offen sc1
    buffer_load_dwordx4 v[140:143], v62, s[68:71], s18 offen sc1
    s_waitcnt vmcnt(11)
    v_xor_b32 v80, s76, v144
    v_xor_b32 v81, s77, v145
    v_xor_b32 v82, s78, v146
    v_xor_b32 v83, s79, v147
    v_or3_b32 v60, v80, v81, v82
    v_or_b32 v60, v60, v83
    s_waitcnt vmcnt(10)
    v_xor_b32 v84, s76, v148
    v_xor_b32 v85, s77, v149
    v_xor_b32 v86, s78, v150
    v_xor_b32 v87, s79, v151
    v_or3_b32 v60, v60, v84, v85
    v_or3_b32 v60, v60, v86, v87
    v_pk_add_f32 v[80:81], v[80:81], v[84:85]
    v_pk_add_f32 v[82:83], v[82:83], v[86:87]
    s_waitcnt vmcnt(9)
    v_xor_b32 v88, s76, v152
    v_xor_b32 v89, s77, v153
    v_xor_b32 v90, s78, v154
    v_xor_b32 v91, s79, v155
    v_or3_b32 v60, v60, v88, v89
    v_or3_b32 v60, v60, v90, v91
    s_waitcnt vmcnt(8)
    v_xor_b32 v92, s76, v156
    v_xor_b32 v93, s77, v157
    v_xor_b32 v94, s78, v158
    v_xor_b32 v95, s79, v159
    v_or3_b32 v60, v60, v92, v93
    v_or3_b32 v60, v60, v94, v95
    v_pk_add_f32 v[88:89], v[88:89], v[92:93]
    v_pk_add_f32 v[90:91], v[90:91], v[94:95]
    v_and_b32 v60, 0xff, v60
    v_cmp_ne_u32 vcc, 0, v60
    s_cbranch_vccz L_got
    buffer_load_dwordx4 v[144:147], v62, s[68:71], 0 offen sc1
    buffer_load_dwordx4 v[148:151], v62, s[68:71], s16 offen sc1
    buffer_load_dwordx4 v[152:155], v62, s[68:71], s17 offen sc1
    buffer_load_dwordx4 v[156:159], v62, s[68:71], s18 offen sc1
    s_waitcnt vmcnt(11)
    v_xor_b32 v80, s76, v160
    v_xor_b32 v81, s77, v161
    v_xor_b32 v82, s78, v162
    v_xor_b32 v83, s79, v163
    v_or3_b32 v60, v80, v81, v82
    v_or_b32 v60, v60, v83
    s_waitcnt vmcnt(10)
    v_xor_b32 v84, s76, v164
    v_xor_b32 v85, s77, v165
    v_xor_b32 v86, s78, v166
    v_xor_b32 v87, s79, v167
    v_or3_b32 v60, v60, v84, v85
    v_or3_b32 v60, v60, v86, v87
    v_pk_add_f32 v[80:81], v[80:81], v[84:85]
    v_pk_add_f32 v[82:83], v[82:83], v[86:87]
    s_waitcnt vmcnt(9)
    v_xor_b32 v88, s76, v168
    v_xor_b32 v89, s77, v169
    v_xor_b32 v90, s78, v170
    v_xor_b32 v91, s79, v171
    v_or3_b32 v60, v60, v88, v89
    v_or3_b32 v60, v60, v90, v91
    s_waitcnt vmcnt(8)
    v_xor_b32 v92, s76, v172
    v_xor_b32 v93, s77, v173
    v_xor_b32 v94, s78, v174
    v_xor_b32 v95, s79, v175
    v_or3_b32 v60, v60, v92, v93
    v_or3_b32 v60, v60, v94, v95
    v_pk_add_f32 v[88:89], v[88:89], v[92:93]
    v_pk_add_f32 v[90:91], v[90:91], v[94:95]
    v_and_b32 v60, 0xff, v60
    v_cmp_ne_u32 vcc, 0, v60
    s_cbranch_vccz L_got
    s_sub_u32 s92, s92, 1
    s_cbranch_scc0 L_poll
L_got:
    v_pk_add_f32 v[80:81], v[80:81], v[88:89]
    v_pk_add_f32 v[82:83], v[82:83], v[90:91]
    s_nop 1
    v_permlane32_swap_b32 v80, v82
    v_permlane32_swap_b32 v81, v83
    v_add_f32 v80, v80, v82
    v_add_f32 v81, v81, v83
    s_nop 1
    v_permlane16_swap_b32 v80, v81
    v_add_f32 v80, v80, v81
    s_nop 1
    v_add_f32_dpp v80, v80, v80 row_ror:8 row_mask:0xf bank_mask:0xf
    s_nop 1
    v_add_f32_dpp v80, v80, v80 row_ror:4 row_mask:0xf bank_mask:0xf
    s_nop 1
    v_add_f32_dpp v80, v80, v80 row_ror:2 row_mask:0xf bank_mask:0xf
    v_cvt_pk_bf16_f32 v80, v80, v80
    buffer_store_short v80, v109, s[72:75], 0 offen
    s_endpgm
L_other:
    s_cmp_lg_u32 s20, 255
    s_cbranch_scc1 L_fin
    v_lshlrev_b32 v24, 6, v0
    v_add_u32 v24, 0x90008, v24
    s_movk_i32 s16, 4096
    s_movk_i32 s17, 8192
    s_movk_i32 s18, 12288
L_ep:
    buffer_load_dwordx2 v[80:81], v24, s[68:71], 0 offen sc1
    buffer_load_dwordx2 v[82:83], v24, s[68:71], s16 offen sc1
    buffer_load_dwordx2 v[84:85], v24, s[68:71], s17 offen sc1
    buffer_load_dwordx2 v[86:87], v24, s[68:71], s18 offen sc1
    s_waitcnt vmcnt(0)
    v_mov_b32 v60, 0
    v_xor_b32 v80, s95, v80
    v_xnor_b32 v81, s95, v81
    v_or3_b32 v60, v60, v80, v81
    v_xor_b32 v82, s95, v82
    v_xnor_b32 v83, s95, v83
    v_or3_b32 v60, v60, v82, v83
    v_xor_b32 v84, s95, v84
    v_xnor_b32 v85, s95, v85
    v_or3_b32 v60, v60, v84, v85
    v_xor_b32 v86, s95, v86
    v_xnor_b32 v87, s95, v87
    v_or3_b32 v60, v60, v86, v87
    v_cmp_ne_u32 vcc, 0, v60
    s_cbranch_vccz L_ep_ok
    s_sub_u32 s92, s92, 1
    s_cbranch_scc0 L_ep
L_ep_ok:
    v_mov_b32 v24, 0xce000
    v_cmp_eq_u32 vcc, 0, v0
    s_nop 1
    v_cndmask_b32 v24, v15, v24, vcc
    v_mov_b32 v25, s95
    buffer_store_dword v25, v24, s[68:71], 0 offen sc1
L_fin:
L_end:
    s_endpgm
.section .rodata,"a"
.p2align 6
.amdhsa_kernel gated_mix__mha_block_cached__dense_activation_mish__decode_kernel
  .amdhsa_next_free_vgpr 512
  .amdhsa_next_free_sgpr 102
  .amdhsa_accum_offset 256
  .amdhsa_group_segment_fixed_size 0
  .amdhsa_kernarg_size 104
  .amdhsa_user_sgpr_count 2
  .amdhsa_user_sgpr_kernarg_segment_ptr 1
  .amdhsa_system_sgpr_workgroup_id_x 1
  .amdhsa_float_denorm_mode_32 3
.end_amdhsa_kernel
```
